```python
import torch

def _softmax(x, axis=-1):
    return torch.softmax(x, dim=axis)
def _gelu(x):
    return torch.nn.functional.gelu(x, approximate="tanh")
def _silu(x):
    return torch.nn.functional.silu(x)
def _sigmoid(x):
    return torch.sigmoid(x)
def _layernorm(x, axis=-1, eps=1e-5):
    m = x.mean(dim=axis, keepdim=True)
    v = x.var(dim=axis, keepdim=True, unbiased=False)
    return (x - m) / torch.sqrt(v + eps)
def _scatter_add(tgt, idx, src, axis=0):
    return tgt.clone().index_add_(axis, idx, src)
def _segment_sum(src, seg, n):
    out = torch.zeros((n,) + src.shape[1:], dtype=src.dtype)
    return out.index_add_(0, seg, src)
def _pad(x, pw):
    flat = tuple(v for pair in reversed(pw) for v in pair)
    return torch.nn.functional.pad(x, flat)

kernel_name = 'sequential_preLN__ssm_conv_h3__glu_gated_reglu__prompt'

def setup_inputs():

    _w = (lambda a: (lambda t: t.to(torch.bfloat16) if t.is_floating_point() else t)(torch.as_tensor(a)))
    def _A_setup():
        B, S, D = 1, 2048, 512
        ks = 4
        return {
            "q": _w((lambda *s: torch.randn(*s, dtype=torch.bfloat16) * 0.05)(B, S, D)),
            "k": _w((lambda *s: torch.randn(*s, dtype=torch.bfloat16) * 0.2)(B, S, D)),
            "v": _w((lambda *s: torch.randn(*s, dtype=torch.bfloat16) * 0.2)(B, S, D)),
            "shift_k": _w((lambda *s: torch.randn(*s, dtype=torch.bfloat16) * 0.2)(D, ks) * 0.5),
            "ssm_k": _w((lambda *s: torch.randn(*s, dtype=torch.bfloat16) * 0.4)(D, S) * (1.0 / S ** 0.5)),
            "ssm_D": _w((lambda *s: torch.randn(*s, dtype=torch.bfloat16) * 0.2)(D)),
        }
    _A_in = _A_setup()

    def _B_setup():
        B, S, D, F = 1, 2048, 512, 1792
        return {
            "x": _w((lambda *s: torch.randn(*s, dtype=torch.bfloat16) * 0.05)(B, S, D)),
            "W_gate": _w((lambda *s: torch.randn(*s, dtype=torch.bfloat16) * 0.2)(D, F) * (2.0 / D) ** 0.5),
            "W_up": _w((lambda *s: torch.randn(*s, dtype=torch.bfloat16) * 0.2)(D, F) * (2.0 / D) ** 0.5),
            "W_down": _w((lambda *s: torch.randn(*s, dtype=torch.bfloat16) * 0.2)(F, D) * (1.0 / F) ** 0.5),
        }
    _B_in = _B_setup()

    return {
        "A_q": _A_in["q"],
        "A_k": _A_in["k"],
        "A_v": _A_in["v"],
        "A_shift_k": _A_in["shift_k"],
        "A_ssm_k": _A_in["ssm_k"],
        "A_ssm_D": _A_in["ssm_D"],
        "B_x": _B_in["x"],
        "B_W_gate": _B_in["W_gate"],
        "B_W_up": _B_in["W_up"],
        "B_W_down": _B_in["W_down"],
    }

def reference(A_q, A_k, A_v, A_shift_k, A_ssm_k, A_ssm_D, B_x, B_W_gate, B_W_up, B_W_down):
    def _A_ref(q, k, v, shift_k, ssm_k, ssm_D):
        B, S, D = q.shape
        ks = shift_k.shape[-1]
        k_pad = _pad(k, ((0, 0), (ks - 1, 0), (0, 0)))
        k_shift = torch.zeros_like(k)
        for t in range(ks):
            k_shift = k_shift + k_pad[:, t:t + S, :] * shift_k[:, ks - 1 - t][None, None, :]
        kv = k_shift * v
        L = 2 * S
        kv_pad = _pad(kv, ((0, 0), (0, S), (0, 0)))
        kf_pad = _pad(ssm_k, ((0, 0), (0, S)))
        kv_f = (lambda x, axes=(-2,-1): torch.fft.rfft2(x.float(), dim=axes))(kv_pad[:, None, :, :], axes=(1, 2))
        kf_f = (lambda x, axes=(-2,-1): torch.fft.rfft2(x.float(), dim=axes))(kf_pad[:, None, :], axes=(1, 2))
        kf_f = (lambda x, *d: x.permute(*d))(kf_f, 1, 2, 0)
        y_f = kv_f * kf_f[None, :, :, :]
        y = (lambda x, s, axes=(-2,-1): torch.fft.irfft2(x, s=s, dim=axes).to(torch.bfloat16))(y_f, (1, L), axes=(1, 2))[:, 0, :S, :]
        y = y + kv * ssm_D[None, None, :]
        return q * y

    def _B_ref(x, W_gate, W_up, W_down):
        gate = torch.einsum("bsd,df->bsf", x, W_gate)
        up = torch.einsum("bsd,df->bsf", x, W_up)
        gate = gate * (lambda x, dt: x.to(dt))(gate > 0, gate.dtype)
        h = gate * up
        return torch.einsum("bsf,fd->bsd", h, W_down)

    x = A_q
    h = x + _A_ref(_layernorm(x, axis=-1), A_k, A_v, A_shift_k, A_ssm_k, A_ssm_D)
    h2 = h + _B_ref(_layernorm(h, axis=-1), B_W_gate, B_W_up, B_W_down)
    return h2
```

```asm
; @launch kernel=k1_kernel grid=(256,1,1) block=(256,1,1) lds=0
; @launch kernel=k2_kernel grid=(256,1,1) block=(256,1,1) lds=88576
; @launch kernel=k3_kernel grid=(256,1,1) block=(256,1,1) lds=1024
; @launch kernel=k4_kernel grid=(448,1,1) block=(256,1,1) lds=65536
; @launch kernel=k5_kernel grid=(256,1,1) block=(256,1,1) lds=65536
.amdgcn_target "amdgcn-amd-amdhsa--gfx950"
.text
.globl k1_kernel
.p2align 8
.type k1_kernel,@function
k1_kernel:
    s_cmp_ge_u32 s2, 256
    s_cbranch_scc1 K1_END
    s_load_dwordx4 s[4:7], s[0:1], 8
    s_load_dwordx2 s[8:9], s[0:1], 24
    s_load_dwordx2 s[10:11], s[0:1], 96
    v_and_b32 v1, 31, v0
    v_lshrrev_b32 v2, 5, v0
    s_and_b32 s3, s2, 31
    s_lshr_b32 s12, s2, 5
    s_lshl_b32 s13, s12, 7
    v_lshlrev_b32 v3, 2, v1
    v_add_u32 v3, s13, v3
    s_lshl_b32 s14, s3, 6
    v_lshlrev_b32 v4, 3, v2
    v_add_u32 v4, s14, v4
    v_lshlrev_b32 v5, 10, v4
    v_add_u32 v5, v5, v3
    v_subrev_u32 v6, 3072, v5
    v_add_u32 v7, 4096, v5
    v_lshlrev_b32 v8, 2, v3
    s_waitcnt lgkmcnt(0)

    s_mov_b32 s16, s4
    s_and_b32 s17, s5, 0xffff
    s_mov_b32 s18, 2097152
    s_mov_b32 s19, 0x00020000

    s_mov_b32 s20, s6
    s_and_b32 s21, s7, 0xffff
    s_mov_b32 s22, 2097152
    s_mov_b32 s23, 0x00020000

    s_mov_b32 s24, s8
    s_and_b32 s25, s9, 0xffff
    s_mov_b32 s26, 4096
    s_mov_b32 s27, 0x00020000

    s_mov_b32 s28, s10
    s_and_b32 s29, s11, 0xffff
    s_mov_b32 s30, 2097152
    s_mov_b32 s31, 0x00020000

    buffer_load_dword v16, v6, s[16:19], 0 offen offset:0
    buffer_load_dword v17, v6, s[16:19], 0 offen offset:1024
    buffer_load_dword v18, v6, s[16:19], 0 offen offset:2048
    buffer_load_dword v19, v5, s[16:19], 0 offen offset:0
    buffer_load_dword v20, v5, s[16:19], 0 offen offset:1024
    buffer_load_dword v21, v5, s[16:19], 0 offen offset:2048
    buffer_load_dword v22, v5, s[16:19], 0 offen offset:3072
    buffer_load_dword v23, v7, s[16:19], 0 offen offset:0
    buffer_load_dword v24, v7, s[16:19], 0 offen offset:1024
    buffer_load_dword v25, v7, s[16:19], 0 offen offset:2048
    buffer_load_dword v26, v7, s[16:19], 0 offen offset:3072
    buffer_load_dword v28, v5, s[20:23], 0 offen offset:0
    buffer_load_dword v29, v5, s[20:23], 0 offen offset:1024
    buffer_load_dword v30, v5, s[20:23], 0 offen offset:2048
    buffer_load_dword v31, v5, s[20:23], 0 offen offset:3072
    buffer_load_dword v32, v7, s[20:23], 0 offen offset:0
    buffer_load_dword v33, v7, s[20:23], 0 offen offset:1024
    buffer_load_dword v34, v7, s[20:23], 0 offen offset:2048
    buffer_load_dword v35, v7, s[20:23], 0 offen offset:3072
    buffer_load_dwordx4 v[36:39], v8, s[24:27], 0 offen
    s_waitcnt vmcnt(0)
    v_lshlrev_b32 v40, 16, v36
    v_and_b32 v41, 0xffff0000, v36
    v_lshlrev_b32 v42, 16, v37
    v_and_b32 v43, 0xffff0000, v37
    v_lshlrev_b32 v44, 16, v38
    v_and_b32 v45, 0xffff0000, v38
    v_lshlrev_b32 v46, 16, v39
    v_and_b32 v47, 0xffff0000, v39

    v_lshlrev_b32 v48, 16, v16
    v_and_b32 v60, 0xffff0000, v16
    v_lshlrev_b32 v49, 16, v17
    v_and_b32 v61, 0xffff0000, v17
    v_lshlrev_b32 v50, 16, v18
    v_and_b32 v62, 0xffff0000, v18
    v_lshlrev_b32 v51, 16, v19
    v_and_b32 v63, 0xffff0000, v19
    v_lshlrev_b32 v52, 16, v20
    v_and_b32 v64, 0xffff0000, v20
    v_lshlrev_b32 v53, 16, v21
    v_and_b32 v65, 0xffff0000, v21
    v_lshlrev_b32 v54, 16, v22
    v_and_b32 v66, 0xffff0000, v22
    v_lshlrev_b32 v55, 16, v23
    v_and_b32 v67, 0xffff0000, v23
    v_lshlrev_b32 v56, 16, v24
    v_and_b32 v68, 0xffff0000, v24
    v_lshlrev_b32 v57, 16, v25
    v_and_b32 v69, 0xffff0000, v25
    v_lshlrev_b32 v58, 16, v26
    v_and_b32 v70, 0xffff0000, v26
    v_lshlrev_b32 v72, 16, v28
    v_and_b32 v80, 0xffff0000, v28
    v_lshlrev_b32 v73, 16, v29
    v_and_b32 v81, 0xffff0000, v29
    v_lshlrev_b32 v74, 16, v30
    v_and_b32 v82, 0xffff0000, v30
    v_lshlrev_b32 v75, 16, v31
    v_and_b32 v83, 0xffff0000, v31
    v_lshlrev_b32 v76, 16, v32
    v_and_b32 v84, 0xffff0000, v32
    v_lshlrev_b32 v77, 16, v33
    v_and_b32 v85, 0xffff0000, v33
    v_lshlrev_b32 v78, 16, v34
    v_and_b32 v86, 0xffff0000, v34
    v_lshlrev_b32 v79, 16, v35
    v_and_b32 v87, 0xffff0000, v35
    v_mul_f32 v96, v48, v43
    v_mul_f32 v97, v60, v47
    v_cvt_pk_bf16_f32 v98, v96, v97
    v_lshlrev_b32 v100, 16, v98
    v_and_b32 v101, 0xffff0000, v98

    v_mul_f32 v96, v49, v42
    v_mul_f32 v97, v61, v46
    v_cvt_pk_bf16_f32 v98, v96, v97
    v_lshlrev_b32 v96, 16, v98
    v_and_b32 v97, 0xffff0000, v98
    v_add_f32 v100, v100, v96
    v_add_f32 v101, v101, v97
    v_cvt_pk_bf16_f32 v98, v100, v101
    v_lshlrev_b32 v100, 16, v98
    v_and_b32 v101, 0xffff0000, v98

    v_mul_f32 v96, v50, v41
    v_mul_f32 v97, v62, v45
    v_cvt_pk_bf16_f32 v98, v96, v97
    v_lshlrev_b32 v96, 16, v98
    v_and_b32 v97, 0xffff0000, v98
    v_add_f32 v100, v100, v96
    v_add_f32 v101, v101, v97
    v_cvt_pk_bf16_f32 v98, v100, v101
    v_lshlrev_b32 v100, 16, v98
    v_and_b32 v101, 0xffff0000, v98

    v_mul_f32 v96, v51, v40
    v_mul_f32 v97, v63, v44
    v_cvt_pk_bf16_f32 v98, v96, v97
    v_lshlrev_b32 v96, 16, v98
    v_and_b32 v97, 0xffff0000, v98
    v_add_f32 v100, v100, v96
    v_add_f32 v101, v101, v97
    v_cvt_pk_bf16_f32 v98, v100, v101
    v_lshlrev_b32 v100, 16, v98
    v_and_b32 v101, 0xffff0000, v98

    v_mul_f32 v100, v100, v72
    v_mul_f32 v101, v101, v80
    v_cvt_pk_bf16_f32 v88, v100, v101

    v_mul_f32 v96, v49, v43
    v_mul_f32 v97, v61, v47
    v_cvt_pk_bf16_f32 v98, v96, v97
    v_lshlrev_b32 v100, 16, v98
    v_and_b32 v101, 0xffff0000, v98

    v_mul_f32 v96, v50, v42
    v_mul_f32 v97, v62, v46
    v_cvt_pk_bf16_f32 v98, v96, v97
    v_lshlrev_b32 v96, 16, v98
    v_and_b32 v97, 0xffff0000, v98
    v_add_f32 v100, v100, v96
    v_add_f32 v101, v101, v97
    v_cvt_pk_bf16_f32 v98, v100, v101
    v_lshlrev_b32 v100, 16, v98
    v_and_b32 v101, 0xffff0000, v98

    v_mul_f32 v96, v51, v41
    v_mul_f32 v97, v63, v45
    v_cvt_pk_bf16_f32 v98, v96, v97
    v_lshlrev_b32 v96, 16, v98
    v_and_b32 v97, 0xffff0000, v98
    v_add_f32 v100, v100, v96
    v_add_f32 v101, v101, v97
    v_cvt_pk_bf16_f32 v98, v100, v101
    v_lshlrev_b32 v100, 16, v98
    v_and_b32 v101, 0xffff0000, v98

    v_mul_f32 v96, v52, v40
    v_mul_f32 v97, v64, v44
    v_cvt_pk_bf16_f32 v98, v96, v97
    v_lshlrev_b32 v96, 16, v98
    v_and_b32 v97, 0xffff0000, v98
    v_add_f32 v100, v100, v96
    v_add_f32 v101, v101, v97
    v_cvt_pk_bf16_f32 v98, v100, v101
    v_lshlrev_b32 v100, 16, v98
    v_and_b32 v101, 0xffff0000, v98

    v_mul_f32 v100, v100, v73
    v_mul_f32 v101, v101, v81
    v_cvt_pk_bf16_f32 v89, v100, v101

    v_mul_f32 v96, v50, v43
    v_mul_f32 v97, v62, v47
    v_cvt_pk_bf16_f32 v98, v96, v97
    v_lshlrev_b32 v100, 16, v98
    v_and_b32 v101, 0xffff0000, v98

    v_mul_f32 v96, v51, v42
    v_mul_f32 v97, v63, v46
    v_cvt_pk_bf16_f32 v98, v96, v97
    v_lshlrev_b32 v96, 16, v98
    v_and_b32 v97, 0xffff0000, v98
    v_add_f32 v100, v100, v96
    v_add_f32 v101, v101, v97
    v_cvt_pk_bf16_f32 v98, v100, v101
    v_lshlrev_b32 v100, 16, v98
    v_and_b32 v101, 0xffff0000, v98

    v_mul_f32 v96, v52, v41
    v_mul_f32 v97, v64, v45
    v_cvt_pk_bf16_f32 v98, v96, v97
    v_lshlrev_b32 v96, 16, v98
    v_and_b32 v97, 0xffff0000, v98
    v_add_f32 v100, v100, v96
    v_add_f32 v101, v101, v97
    v_cvt_pk_bf16_f32 v98, v100, v101
    v_lshlrev_b32 v100, 16, v98
    v_and_b32 v101, 0xffff0000, v98

    v_mul_f32 v96, v53, v40
    v_mul_f32 v97, v65, v44
    v_cvt_pk_bf16_f32 v98, v96, v97
    v_lshlrev_b32 v96, 16, v98
    v_and_b32 v97, 0xffff0000, v98
    v_add_f32 v100, v100, v96
    v_add_f32 v101, v101, v97
    v_cvt_pk_bf16_f32 v98, v100, v101
    v_lshlrev_b32 v100, 16, v98
    v_and_b32 v101, 0xffff0000, v98

    v_mul_f32 v100, v100, v74
    v_mul_f32 v101, v101, v82
    v_cvt_pk_bf16_f32 v90, v100, v101

    v_mul_f32 v96, v51, v43
    v_mul_f32 v97, v63, v47
    v_cvt_pk_bf16_f32 v98, v96, v97
    v_lshlrev_b32 v100, 16, v98
    v_and_b32 v101, 0xffff0000, v98

    v_mul_f32 v96, v52, v42
    v_mul_f32 v97, v64, v46
    v_cvt_pk_bf16_f32 v98, v96, v97
    v_lshlrev_b32 v96, 16, v98
    v_and_b32 v97, 0xffff0000, v98
    v_add_f32 v100, v100, v96
    v_add_f32 v101, v101, v97
    v_cvt_pk_bf16_f32 v98, v100, v101
    v_lshlrev_b32 v100, 16, v98
    v_and_b32 v101, 0xffff0000, v98

    v_mul_f32 v96, v53, v41
    v_mul_f32 v97, v65, v45
    v_cvt_pk_bf16_f32 v98, v96, v97
    v_lshlrev_b32 v96, 16, v98
    v_and_b32 v97, 0xffff0000, v98
    v_add_f32 v100, v100, v96
    v_add_f32 v101, v101, v97
    v_cvt_pk_bf16_f32 v98, v100, v101
    v_lshlrev_b32 v100, 16, v98
    v_and_b32 v101, 0xffff0000, v98

    v_mul_f32 v96, v54, v40
    v_mul_f32 v97, v66, v44
    v_cvt_pk_bf16_f32 v98, v96, v97
    v_lshlrev_b32 v96, 16, v98
    v_and_b32 v97, 0xffff0000, v98
    v_add_f32 v100, v100, v96
    v_add_f32 v101, v101, v97
    v_cvt_pk_bf16_f32 v98, v100, v101
    v_lshlrev_b32 v100, 16, v98
    v_and_b32 v101, 0xffff0000, v98

    v_mul_f32 v100, v100, v75
    v_mul_f32 v101, v101, v83
    v_cvt_pk_bf16_f32 v91, v100, v101

    v_mul_f32 v96, v52, v43
    v_mul_f32 v97, v64, v47
    v_cvt_pk_bf16_f32 v98, v96, v97
    v_lshlrev_b32 v100, 16, v98
    v_and_b32 v101, 0xffff0000, v98

    v_mul_f32 v96, v53, v42
    v_mul_f32 v97, v65, v46
    v_cvt_pk_bf16_f32 v98, v96, v97
    v_lshlrev_b32 v96, 16, v98
    v_and_b32 v97, 0xffff0000, v98
    v_add_f32 v100, v100, v96
    v_add_f32 v101, v101, v97
    v_cvt_pk_bf16_f32 v98, v100, v101
    v_lshlrev_b32 v100, 16, v98
    v_and_b32 v101, 0xffff0000, v98

    v_mul_f32 v96, v54, v41
    v_mul_f32 v97, v66, v45
    v_cvt_pk_bf16_f32 v98, v96, v97
    v_lshlrev_b32 v96, 16, v98
    v_and_b32 v97, 0xffff0000, v98
    v_add_f32 v100, v100, v96
    v_add_f32 v101, v101, v97
    v_cvt_pk_bf16_f32 v98, v100, v101
    v_lshlrev_b32 v100, 16, v98
    v_and_b32 v101, 0xffff0000, v98

    v_mul_f32 v96, v55, v40
    v_mul_f32 v97, v67, v44
    v_cvt_pk_bf16_f32 v98, v96, v97
    v_lshlrev_b32 v96, 16, v98
    v_and_b32 v97, 0xffff0000, v98
    v_add_f32 v100, v100, v96
    v_add_f32 v101, v101, v97
    v_cvt_pk_bf16_f32 v98, v100, v101
    v_lshlrev_b32 v100, 16, v98
    v_and_b32 v101, 0xffff0000, v98

    v_mul_f32 v100, v100, v76
    v_mul_f32 v101, v101, v84
    v_cvt_pk_bf16_f32 v92, v100, v101

    v_mul_f32 v96, v53, v43
    v_mul_f32 v97, v65, v47
    v_cvt_pk_bf16_f32 v98, v96, v97
    v_lshlrev_b32 v100, 16, v98
    v_and_b32 v101, 0xffff0000, v98

    v_mul_f32 v96, v54, v42
    v_mul_f32 v97, v66, v46
    v_cvt_pk_bf16_f32 v98, v96, v97
    v_lshlrev_b32 v96, 16, v98
    v_and_b32 v97, 0xffff0000, v98
    v_add_f32 v100, v100, v96
    v_add_f32 v101, v101, v97
    v_cvt_pk_bf16_f32 v98, v100, v101
    v_lshlrev_b32 v100, 16, v98
    v_and_b32 v101, 0xffff0000, v98

    v_mul_f32 v96, v55, v41
    v_mul_f32 v97, v67, v45
    v_cvt_pk_bf16_f32 v98, v96, v97
    v_lshlrev_b32 v96, 16, v98
    v_and_b32 v97, 0xffff0000, v98
    v_add_f32 v100, v100, v96
    v_add_f32 v101, v101, v97
    v_cvt_pk_bf16_f32 v98, v100, v101
    v_lshlrev_b32 v100, 16, v98
    v_and_b32 v101, 0xffff0000, v98

    v_mul_f32 v96, v56, v40
    v_mul_f32 v97, v68, v44
    v_cvt_pk_bf16_f32 v98, v96, v97
    v_lshlrev_b32 v96, 16, v98
    v_and_b32 v97, 0xffff0000, v98
    v_add_f32 v100, v100, v96
    v_add_f32 v101, v101, v97
    v_cvt_pk_bf16_f32 v98, v100, v101
    v_lshlrev_b32 v100, 16, v98
    v_and_b32 v101, 0xffff0000, v98

    v_mul_f32 v100, v100, v77
    v_mul_f32 v101, v101, v85
    v_cvt_pk_bf16_f32 v93, v100, v101

    v_mul_f32 v96, v54, v43
    v_mul_f32 v97, v66, v47
    v_cvt_pk_bf16_f32 v98, v96, v97
    v_lshlrev_b32 v100, 16, v98
    v_and_b32 v101, 0xffff0000, v98

    v_mul_f32 v96, v55, v42
    v_mul_f32 v97, v67, v46
    v_cvt_pk_bf16_f32 v98, v96, v97
    v_lshlrev_b32 v96, 16, v98
    v_and_b32 v97, 0xffff0000, v98
    v_add_f32 v100, v100, v96
    v_add_f32 v101, v101, v97
    v_cvt_pk_bf16_f32 v98, v100, v101
    v_lshlrev_b32 v100, 16, v98
    v_and_b32 v101, 0xffff0000, v98

    v_mul_f32 v96, v56, v41
    v_mul_f32 v97, v68, v45
    v_cvt_pk_bf16_f32 v98, v96, v97
    v_lshlrev_b32 v96, 16, v98
    v_and_b32 v97, 0xffff0000, v98
    v_add_f32 v100, v100, v96
    v_add_f32 v101, v101, v97
    v_cvt_pk_bf16_f32 v98, v100, v101
    v_lshlrev_b32 v100, 16, v98
    v_and_b32 v101, 0xffff0000, v98

    v_mul_f32 v96, v57, v40
    v_mul_f32 v97, v69, v44
    v_cvt_pk_bf16_f32 v98, v96, v97
    v_lshlrev_b32 v96, 16, v98
    v_and_b32 v97, 0xffff0000, v98
    v_add_f32 v100, v100, v96
    v_add_f32 v101, v101, v97
    v_cvt_pk_bf16_f32 v98, v100, v101
    v_lshlrev_b32 v100, 16, v98
    v_and_b32 v101, 0xffff0000, v98

    v_mul_f32 v100, v100, v78
    v_mul_f32 v101, v101, v86
    v_cvt_pk_bf16_f32 v94, v100, v101

    v_mul_f32 v96, v55, v43
    v_mul_f32 v97, v67, v47
    v_cvt_pk_bf16_f32 v98, v96, v97
    v_lshlrev_b32 v100, 16, v98
    v_and_b32 v101, 0xffff0000, v98

    v_mul_f32 v96, v56, v42
    v_mul_f32 v97, v68, v46
    v_cvt_pk_bf16_f32 v98, v96, v97
    v_lshlrev_b32 v96, 16, v98
    v_and_b32 v97, 0xffff0000, v98
    v_add_f32 v100, v100, v96
    v_add_f32 v101, v101, v97
    v_cvt_pk_bf16_f32 v98, v100, v101
    v_lshlrev_b32 v100, 16, v98
    v_and_b32 v101, 0xffff0000, v98

    v_mul_f32 v96, v57, v41
    v_mul_f32 v97, v69, v45
    v_cvt_pk_bf16_f32 v98, v96, v97
    v_lshlrev_b32 v96, 16, v98
    v_and_b32 v97, 0xffff0000, v98
    v_add_f32 v100, v100, v96
    v_add_f32 v101, v101, v97
    v_cvt_pk_bf16_f32 v98, v100, v101
    v_lshlrev_b32 v100, 16, v98
    v_and_b32 v101, 0xffff0000, v98

    v_mul_f32 v96, v58, v40
    v_mul_f32 v97, v70, v44
    v_cvt_pk_bf16_f32 v98, v96, v97
    v_lshlrev_b32 v96, 16, v98
    v_and_b32 v97, 0xffff0000, v98
    v_add_f32 v100, v100, v96
    v_add_f32 v101, v101, v97
    v_cvt_pk_bf16_f32 v98, v100, v101
    v_lshlrev_b32 v100, 16, v98
    v_and_b32 v101, 0xffff0000, v98

    v_mul_f32 v100, v100, v79
    v_mul_f32 v101, v101, v87
    v_cvt_pk_bf16_f32 v95, v100, v101

    s_mov_b32 s32, 0x05040100
    s_mov_b32 s33, 0x07060302
    v_perm_b32 v104, v89, v88, s32
    v_perm_b32 v108, v89, v88, s33
    v_perm_b32 v105, v91, v90, s32
    v_perm_b32 v109, v91, v90, s33
    v_perm_b32 v106, v93, v92, s32
    v_perm_b32 v110, v93, v92, s33
    v_perm_b32 v107, v95, v94, s32
    v_perm_b32 v111, v95, v94, s33
    v_lshlrev_b32 v9, 11, v3
    v_lshlrev_b32 v10, 1, v4
    v_add_u32 v9, v9, v10
    v_add_u32 v10, 4096, v9
    buffer_store_dwordx4 v[104:107], v9, s[28:31], 0 offen
    buffer_store_dwordx4 v[108:111], v10, s[28:31], 0 offen

K1_END:
    s_endpgm
.globl k2_kernel
.p2align 8
.type k2_kernel,@function
k2_kernel:
    s_cmp_ge_u32 s2, 256
    s_cbranch_scc1 K2_END
    s_load_dwordx2 s[4:5], s[0:1], 32
    s_load_dwordx2 s[6:7], s[0:1], 96
    v_lshrrev_b32 v1, 7, v0
    v_and_b32 v2, 127, v0
    v_lshrrev_b32 v3, 6, v0
    v_and_b32 v3, 1, v3
    s_mov_b32 s27, 0xffff
    v_readfirstlane_b32 s20, v1
    v_readfirstlane_b32 s21, v3
    v_mov_b32 v8, 0
    v_mov_b32 v9, 0
    v_mov_b32 v10, 0
    v_mov_b32 v11, 0
    v_lshlrev_b32 v4, 4, v0

    v_add_u32 v14, 65536, v4
    ds_write_b128 v4, v[8:11] offset:0
    ds_write_b128 v4, v[8:11] offset:4096
    ds_write_b128 v4, v[8:11] offset:8192
    ds_write_b128 v4, v[8:11] offset:12288
    ds_write_b128 v4, v[8:11] offset:16384
    ds_write_b128 v4, v[8:11] offset:20480
    ds_write_b128 v4, v[8:11] offset:24576
    ds_write_b128 v4, v[8:11] offset:28672
    ds_write_b128 v4, v[8:11] offset:32768
    ds_write_b128 v4, v[8:11] offset:36864
    ds_write_b128 v4, v[8:11] offset:40960
    ds_write_b128 v4, v[8:11] offset:45056
    ds_write_b128 v4, v[8:11] offset:49152
    ds_write_b128 v4, v[8:11] offset:53248
    ds_write_b128 v4, v[8:11] offset:57344
    ds_write_b128 v4, v[8:11] offset:61440
    ds_write_b128 v14, v[8:11] offset:0
    ds_write_b128 v14, v[8:11] offset:4096
    ds_write_b128 v14, v[8:11] offset:8192
    ds_write_b128 v14, v[8:11] offset:12288
    ds_write_b128 v14, v[8:11] offset:16384
    v_cmp_gt_u32 vcc, 2560, v4
    s_and_saveexec_b64 s[22:23], vcc
    ds_write_b128 v14, v[8:11] offset:20480
    s_mov_b64 exec, s[22:23]
    s_waitcnt lgkmcnt(0)
    s_lshl_b32 s24, s2, 1
    s_add_u32 s24, s24, s20
    s_lshl_b32 s25, s24, 12
    s_add_u32 s8, s4, s25
    s_addc_u32 s9, s5, 0
    s_add_u32 s10, s6, s25
    s_addc_u32 s11, s7, 0
    s_mul_i32 s26, s20, 44288

    s_mov_b32 s12, s8
    s_and_b32 s13, s9, 0xffff
    s_mov_b32 s14, 4096
    s_mov_b32 s15, 0x00020000

    s_mov_b32 s16, s10
    s_and_b32 s17, s11, 0xffff
    s_mov_b32 s18, 4096
    s_mov_b32 s19, 0x00020000

    v_lshlrev_b32 v5, 5, v2
    v_subrev_u32 v6, 32, v5
    buffer_load_dwordx4 v[16:19], v6, s[12:15], 0 offen
    buffer_load_dwordx4 v[20:23], v6, s[12:15], 0 offen offset:16
    buffer_load_dwordx4 v[24:27], v5, s[12:15], 0 offen
    buffer_load_dwordx4 v[28:31], v5, s[12:15], 0 offen offset:16
    buffer_load_dwordx4 v[32:35], v5, s[12:15], 0 offen offset:32
    buffer_load_dwordx4 v[36:39], v5, s[16:19], 0 offen
    buffer_load_dwordx4 v[40:43], v5, s[16:19], 0 offen offset:16
    s_barrier
    v_lshrrev_b32 v7, 2, v2
    v_mul_u32_u24 v7, 144, v7
    v_and_b32 v12, 3, v2
    v_lshlrev_b32 v12, 5, v12
    v_add3_u32 v7, v7, v12, s26
    v_add_u32 v7, 4608, v7
    v_lshlrev_b32 v13, 5, v2
    v_sub_u32 v13, 13344, v13
    v_add_u32 v13, s26, v13
    s_waitcnt vmcnt(0)
    ds_write_b128 v7, v[36:39]
    ds_write_b128 v7, v[40:43] offset:16

    v_bfi_b32 v44, s27, v24, v23
    v_bfi_b32 v45, s27, v23, v22
    v_bfi_b32 v46, s27, v22, v21
    v_bfi_b32 v47, s27, v21, v20
    ds_write_b128 v13, v[44:47] offset:64
    v_alignbit_b32 v48, v23, v23, 16
    v_alignbit_b32 v49, v22, v22, 16
    v_alignbit_b32 v50, v21, v21, 16
    v_alignbit_b32 v51, v20, v20, 16
    ds_write_b128 v13, v[48:51] offset:4448
    v_bfi_b32 v44, s27, v23, v22
    v_bfi_b32 v45, s27, v22, v21
    v_bfi_b32 v46, s27, v21, v20
    v_bfi_b32 v47, s27, v20, v19
    ds_write_b128 v13, v[44:47] offset:8832
    v_alignbit_b32 v48, v22, v22, 16
    v_alignbit_b32 v49, v21, v21, 16
    v_alignbit_b32 v50, v20, v20, 16
    v_alignbit_b32 v51, v19, v19, 16
    ds_write_b128 v13, v[48:51] offset:13216
    v_bfi_b32 v44, s27, v22, v21
    v_bfi_b32 v45, s27, v21, v20
    v_bfi_b32 v46, s27, v20, v19
    v_bfi_b32 v47, s27, v19, v18
    ds_write_b128 v13, v[44:47] offset:17600
    v_alignbit_b32 v48, v21, v21, 16
    v_alignbit_b32 v49, v20, v20, 16
    v_alignbit_b32 v50, v19, v19, 16
    v_alignbit_b32 v51, v18, v18, 16
    ds_write_b128 v13, v[48:51] offset:21984
    v_bfi_b32 v44, s27, v21, v20
    v_bfi_b32 v45, s27, v20, v19
    v_bfi_b32 v46, s27, v19, v18
    v_bfi_b32 v47, s27, v18, v17
    ds_write_b128 v13, v[44:47] offset:26368
    v_alignbit_b32 v48, v20, v20, 16
    v_alignbit_b32 v49, v19, v19, 16
    v_alignbit_b32 v50, v18, v18, 16
    v_alignbit_b32 v51, v17, v17, 16
    ds_write_b128 v13, v[48:51] offset:30752
    v_bfi_b32 v44, s27, v28, v27
    v_bfi_b32 v45, s27, v27, v26
    v_bfi_b32 v46, s27, v26, v25
    v_bfi_b32 v47, s27, v25, v24
    ds_write_b128 v13, v[44:47] offset:48
    v_alignbit_b32 v48, v27, v27, 16
    v_alignbit_b32 v49, v26, v26, 16
    v_alignbit_b32 v50, v25, v25, 16
    v_alignbit_b32 v51, v24, v24, 16
    ds_write_b128 v13, v[48:51] offset:4432
    v_bfi_b32 v44, s27, v27, v26
    v_bfi_b32 v45, s27, v26, v25
    v_bfi_b32 v46, s27, v25, v24
    v_bfi_b32 v47, s27, v24, v23
    ds_write_b128 v13, v[44:47] offset:8816
    v_alignbit_b32 v48, v26, v26, 16
    v_alignbit_b32 v49, v25, v25, 16
    v_alignbit_b32 v50, v24, v24, 16
    v_alignbit_b32 v51, v23, v23, 16
    ds_write_b128 v13, v[48:51] offset:13200
    v_bfi_b32 v44, s27, v26, v25
    v_bfi_b32 v45, s27, v25, v24
    v_bfi_b32 v46, s27, v24, v23
    v_bfi_b32 v47, s27, v23, v22
    ds_write_b128 v13, v[44:47] offset:17584
    v_alignbit_b32 v48, v25, v25, 16
    v_alignbit_b32 v49, v24, v24, 16
    v_alignbit_b32 v50, v23, v23, 16
    v_alignbit_b32 v51, v22, v22, 16
    ds_write_b128 v13, v[48:51] offset:21968
    v_bfi_b32 v44, s27, v25, v24
    v_bfi_b32 v45, s27, v24, v23
    v_bfi_b32 v46, s27, v23, v22
    v_bfi_b32 v47, s27, v22, v21
    ds_write_b128 v13, v[44:47] offset:26352
    v_alignbit_b32 v48, v24, v24, 16
    v_alignbit_b32 v49, v23, v23, 16
    v_alignbit_b32 v50, v22, v22, 16
    v_alignbit_b32 v51, v21, v21, 16
    ds_write_b128 v13, v[48:51] offset:30736
    v_bfi_b32 v44, s27, v32, v31
    v_bfi_b32 v45, s27, v31, v30
    v_bfi_b32 v46, s27, v30, v29
    v_bfi_b32 v47, s27, v29, v28
    ds_write_b128 v13, v[44:47] offset:32
    v_alignbit_b32 v48, v31, v31, 16
    v_alignbit_b32 v49, v30, v30, 16
    v_alignbit_b32 v50, v29, v29, 16
    v_alignbit_b32 v51, v28, v28, 16
    ds_write_b128 v13, v[48:51] offset:4416
    v_bfi_b32 v44, s27, v31, v30
    v_bfi_b32 v45, s27, v30, v29
    v_bfi_b32 v46, s27, v29, v28
    v_bfi_b32 v47, s27, v28, v27
    ds_write_b128 v13, v[44:47] offset:8800
    v_alignbit_b32 v48, v30, v30, 16
    v_alignbit_b32 v49, v29, v29, 16
    v_alignbit_b32 v50, v28, v28, 16
    v_alignbit_b32 v51, v27, v27, 16
    ds_write_b128 v13, v[48:51] offset:13184
    v_bfi_b32 v44, s27, v30, v29
    v_bfi_b32 v45, s27, v29, v28
    v_bfi_b32 v46, s27, v28, v27
    v_bfi_b32 v47, s27, v27, v26
    ds_write_b128 v13, v[44:47] offset:17568
    v_alignbit_b32 v48, v29, v29, 16
    v_alignbit_b32 v49, v28, v28, 16
    v_alignbit_b32 v50, v27, v27, 16
    v_alignbit_b32 v51, v26, v26, 16
    ds_write_b128 v13, v[48:51] offset:21952
    v_bfi_b32 v44, s27, v29, v28
    v_bfi_b32 v45, s27, v28, v27
    v_bfi_b32 v46, s27, v27, v26
    v_bfi_b32 v47, s27, v26, v25
    ds_write_b128 v13, v[44:47] offset:26336
    v_alignbit_b32 v48, v28, v28, 16
    v_alignbit_b32 v49, v27, v27, 16
    v_alignbit_b32 v50, v26, v26, 16
    v_alignbit_b32 v51, v25, v25, 16
    ds_write_b128 v13, v[48:51] offset:30720
    s_waitcnt lgkmcnt(0)
    s_barrier
    v_and_b32 v1, 31, v0
    v_bfe_u32 v2, v0, 5, 1
    v_sub_u32 v3, 0, v1
    v_and_b32 v3, 7, v3
    v_mul_u32_u24 v4, 4384, v3
    v_add_u32 v5, v1, v3
    v_lshlrev_b32 v6, 3, v2
    v_sub_u32 v5, v6, v5
    v_lshlrev_b32 v5, 1, v5
    v_add3_u32 v4, v4, v5, s26
    v_add_u32 v4, 9280, v4
    s_lshl_b32 s28, s21, 11
    v_subrev_u32 v4, s28, v4
    v_mul_u32_u24 v5, 144, v1
    v_lshlrev_b32 v6, 4, v2
    v_add3_u32 v5, v5, v6, s26
    v_add_u32 v5, 144, v5
    s_mul_i32 s29, s21, 2304
    v_subrev_u32 v5, s29, v5

    v_accvgpr_write_b32 a0, 0
    v_accvgpr_write_b32 a1, 0
    v_accvgpr_write_b32 a2, 0
    v_accvgpr_write_b32 a3, 0
    v_accvgpr_write_b32 a4, 0
    v_accvgpr_write_b32 a5, 0
    v_accvgpr_write_b32 a6, 0
    v_accvgpr_write_b32 a7, 0
    v_accvgpr_write_b32 a8, 0
    v_accvgpr_write_b32 a9, 0
    v_accvgpr_write_b32 a10, 0
    v_accvgpr_write_b32 a11, 0
    v_accvgpr_write_b32 a12, 0
    v_accvgpr_write_b32 a13, 0
    v_accvgpr_write_b32 a14, 0
    v_accvgpr_write_b32 a15, 0
    v_accvgpr_write_b32 a16, 0
    v_accvgpr_write_b32 a17, 0
    v_accvgpr_write_b32 a18, 0
    v_accvgpr_write_b32 a19, 0
    v_accvgpr_write_b32 a20, 0
    v_accvgpr_write_b32 a21, 0
    v_accvgpr_write_b32 a22, 0
    v_accvgpr_write_b32 a23, 0
    v_accvgpr_write_b32 a24, 0
    v_accvgpr_write_b32 a25, 0
    v_accvgpr_write_b32 a26, 0
    v_accvgpr_write_b32 a27, 0
    v_accvgpr_write_b32 a28, 0
    v_accvgpr_write_b32 a29, 0
    v_accvgpr_write_b32 a30, 0
    v_accvgpr_write_b32 a31, 0
    ds_read_b128 v[52:55], v4 offset:4224
    ds_read_b128 v[56:59], v4 offset:4192
    ds_read_b128 v[60:63], v4 offset:4160
    ds_read_b128 v[16:19], v4 offset:4128
    ds_read_b128 v[20:23], v4 offset:4096
    ds_read_b128 v[24:27], v4 offset:4064
    ds_read_b128 v[64:67], v5 offset:4464
    ds_read_b128 v[68:71], v5 offset:4496
    ds_read_b128 v[72:75], v5 offset:4528
    ds_read_b128 v[76:79], v5 offset:4560
    ds_read_b128 v[28:31], v4 offset:4032
    ds_read_b128 v[32:35], v4 offset:4000
    ds_read_b128 v[36:39], v4 offset:3968
    ds_read_b128 v[40:43], v4 offset:3936
    ds_read_b128 v[80:83], v5 offset:4320
    ds_read_b128 v[84:87], v5 offset:4352
    ds_read_b128 v[88:91], v5 offset:4384
    ds_read_b128 v[92:95], v5 offset:4416
    s_waitcnt lgkmcnt(8)
    v_mfma_f32_32x32x16_bf16 a[0:15], v[16:19], v[64:67], a[0:15]
    v_mfma_f32_32x32x16_bf16 a[16:31], v[24:27], v[64:67], a[16:31]
    v_mfma_f32_32x32x16_bf16 a[0:15], v[60:63], v[68:71], a[0:15]
    v_mfma_f32_32x32x16_bf16 a[16:31], v[20:23], v[68:71], a[16:31]
    v_mfma_f32_32x32x16_bf16 a[0:15], v[56:59], v[72:75], a[0:15]
    v_mfma_f32_32x32x16_bf16 a[16:31], v[16:19], v[72:75], a[16:31]
    v_mfma_f32_32x32x16_bf16 a[0:15], v[52:55], v[76:79], a[0:15]
    v_mfma_f32_32x32x16_bf16 a[16:31], v[60:63], v[76:79], a[16:31]
    ds_read_b128 v[44:47], v4 offset:3904
    ds_read_b128 v[48:51], v4 offset:3872
    ds_read_b128 v[52:55], v4 offset:3840
    ds_read_b128 v[56:59], v4 offset:3808
    ds_read_b128 v[64:67], v5 offset:4176
    ds_read_b128 v[68:71], v5 offset:4208
    ds_read_b128 v[72:75], v5 offset:4240
    ds_read_b128 v[76:79], v5 offset:4272
    s_waitcnt lgkmcnt(8)
    v_mfma_f32_32x32x16_bf16 a[0:15], v[32:35], v[80:83], a[0:15]
    v_mfma_f32_32x32x16_bf16 a[16:31], v[40:43], v[80:83], a[16:31]
    v_mfma_f32_32x32x16_bf16 a[0:15], v[28:31], v[84:87], a[0:15]
    v_mfma_f32_32x32x16_bf16 a[16:31], v[36:39], v[84:87], a[16:31]
    v_mfma_f32_32x32x16_bf16 a[0:15], v[24:27], v[88:91], a[0:15]
    v_mfma_f32_32x32x16_bf16 a[16:31], v[32:35], v[88:91], a[16:31]
    v_mfma_f32_32x32x16_bf16 a[0:15], v[20:23], v[92:95], a[0:15]
    v_mfma_f32_32x32x16_bf16 a[16:31], v[28:31], v[92:95], a[16:31]
    ds_read_b128 v[60:63], v4 offset:3776
    ds_read_b128 v[16:19], v4 offset:3744
    ds_read_b128 v[20:23], v4 offset:3712
    ds_read_b128 v[24:27], v4 offset:3680
    ds_read_b128 v[80:83], v5 offset:4032
    ds_read_b128 v[84:87], v5 offset:4064
    ds_read_b128 v[88:91], v5 offset:4096
    ds_read_b128 v[92:95], v5 offset:4128
    s_waitcnt lgkmcnt(8)
    v_mfma_f32_32x32x16_bf16 a[0:15], v[48:51], v[64:67], a[0:15]
    v_mfma_f32_32x32x16_bf16 a[16:31], v[56:59], v[64:67], a[16:31]
    v_mfma_f32_32x32x16_bf16 a[0:15], v[44:47], v[68:71], a[0:15]
    v_mfma_f32_32x32x16_bf16 a[16:31], v[52:55], v[68:71], a[16:31]
    v_mfma_f32_32x32x16_bf16 a[0:15], v[40:43], v[72:75], a[0:15]
    v_mfma_f32_32x32x16_bf16 a[16:31], v[48:51], v[72:75], a[16:31]
    v_mfma_f32_32x32x16_bf16 a[0:15], v[36:39], v[76:79], a[0:15]
    v_mfma_f32_32x32x16_bf16 a[16:31], v[44:47], v[76:79], a[16:31]
    ds_read_b128 v[28:31], v4 offset:3648
    ds_read_b128 v[32:35], v4 offset:3616
    ds_read_b128 v[36:39], v4 offset:3584
    ds_read_b128 v[40:43], v4 offset:3552
    ds_read_b128 v[64:67], v5 offset:3888
    ds_read_b128 v[68:71], v5 offset:3920
    ds_read_b128 v[72:75], v5 offset:3952
    ds_read_b128 v[76:79], v5 offset:3984
    s_waitcnt lgkmcnt(8)
    v_mfma_f32_32x32x16_bf16 a[0:15], v[16:19], v[80:83], a[0:15]
    v_mfma_f32_32x32x16_bf16 a[16:31], v[24:27], v[80:83], a[16:31]
    v_mfma_f32_32x32x16_bf16 a[0:15], v[60:63], v[84:87], a[0:15]
    v_mfma_f32_32x32x16_bf16 a[16:31], v[20:23], v[84:87], a[16:31]
    v_mfma_f32_32x32x16_bf16 a[0:15], v[56:59], v[88:91], a[0:15]
    v_mfma_f32_32x32x16_bf16 a[16:31], v[16:19], v[88:91], a[16:31]
    v_mfma_f32_32x32x16_bf16 a[0:15], v[52:55], v[92:95], a[0:15]
    v_mfma_f32_32x32x16_bf16 a[16:31], v[60:63], v[92:95], a[16:31]
    ds_read_b128 v[44:47], v4 offset:3520
    ds_read_b128 v[48:51], v4 offset:3488
    ds_read_b128 v[52:55], v4 offset:3456
    ds_read_b128 v[56:59], v4 offset:3424
    ds_read_b128 v[80:83], v5 offset:3744
    ds_read_b128 v[84:87], v5 offset:3776
    ds_read_b128 v[88:91], v5 offset:3808
    ds_read_b128 v[92:95], v5 offset:3840
    s_waitcnt lgkmcnt(8)
    v_mfma_f32_32x32x16_bf16 a[0:15], v[32:35], v[64:67], a[0:15]
    v_mfma_f32_32x32x16_bf16 a[16:31], v[40:43], v[64:67], a[16:31]
    v_mfma_f32_32x32x16_bf16 a[0:15], v[28:31], v[68:71], a[0:15]
    v_mfma_f32_32x32x16_bf16 a[16:31], v[36:39], v[68:71], a[16:31]
    v_mfma_f32_32x32x16_bf16 a[0:15], v[24:27], v[72:75], a[0:15]
    v_mfma_f32_32x32x16_bf16 a[16:31], v[32:35], v[72:75], a[16:31]
    v_mfma_f32_32x32x16_bf16 a[0:15], v[20:23], v[76:79], a[0:15]
    v_mfma_f32_32x32x16_bf16 a[16:31], v[28:31], v[76:79], a[16:31]
    ds_read_b128 v[60:63], v4 offset:3392
    ds_read_b128 v[16:19], v4 offset:3360
    ds_read_b128 v[20:23], v4 offset:3328
    ds_read_b128 v[24:27], v4 offset:3296
    ds_read_b128 v[64:67], v5 offset:3600
    ds_read_b128 v[68:71], v5 offset:3632
    ds_read_b128 v[72:75], v5 offset:3664
    ds_read_b128 v[76:79], v5 offset:3696
    s_waitcnt lgkmcnt(8)
    v_mfma_f32_32x32x16_bf16 a[0:15], v[48:51], v[80:83], a[0:15]
    v_mfma_f32_32x32x16_bf16 a[16:31], v[56:59], v[80:83], a[16:31]
    v_mfma_f32_32x32x16_bf16 a[0:15], v[44:47], v[84:87], a[0:15]
    v_mfma_f32_32x32x16_bf16 a[16:31], v[52:55], v[84:87], a[16:31]
    v_mfma_f32_32x32x16_bf16 a[0:15], v[40:43], v[88:91], a[0:15]
    v_mfma_f32_32x32x16_bf16 a[16:31], v[48:51], v[88:91], a[16:31]
    v_mfma_f32_32x32x16_bf16 a[0:15], v[36:39], v[92:95], a[0:15]
    v_mfma_f32_32x32x16_bf16 a[16:31], v[44:47], v[92:95], a[16:31]
    ds_read_b128 v[28:31], v4 offset:3264
    ds_read_b128 v[32:35], v4 offset:3232
    ds_read_b128 v[36:39], v4 offset:3200
    ds_read_b128 v[40:43], v4 offset:3168
    ds_read_b128 v[80:83], v5 offset:3456
    ds_read_b128 v[84:87], v5 offset:3488
    ds_read_b128 v[88:91], v5 offset:3520
    ds_read_b128 v[92:95], v5 offset:3552
    s_waitcnt lgkmcnt(8)
    v_mfma_f32_32x32x16_bf16 a[0:15], v[16:19], v[64:67], a[0:15]
    v_mfma_f32_32x32x16_bf16 a[16:31], v[24:27], v[64:67], a[16:31]
    v_mfma_f32_32x32x16_bf16 a[0:15], v[60:63], v[68:71], a[0:15]
    v_mfma_f32_32x32x16_bf16 a[16:31], v[20:23], v[68:71], a[16:31]
    v_mfma_f32_32x32x16_bf16 a[0:15], v[56:59], v[72:75], a[0:15]
    v_mfma_f32_32x32x16_bf16 a[16:31], v[16:19], v[72:75], a[16:31]
    v_mfma_f32_32x32x16_bf16 a[0:15], v[52:55], v[76:79], a[0:15]
    v_mfma_f32_32x32x16_bf16 a[16:31], v[60:63], v[76:79], a[16:31]
    ds_read_b128 v[44:47], v4 offset:3136
    ds_read_b128 v[48:51], v4 offset:3104
    ds_read_b128 v[52:55], v4 offset:3072
    ds_read_b128 v[56:59], v4 offset:3040
    ds_read_b128 v[64:67], v5 offset:3312
    ds_read_b128 v[68:71], v5 offset:3344
    ds_read_b128 v[72:75], v5 offset:3376
    ds_read_b128 v[76:79], v5 offset:3408
    s_waitcnt lgkmcnt(8)
    v_mfma_f32_32x32x16_bf16 a[0:15], v[32:35], v[80:83], a[0:15]
    v_mfma_f32_32x32x16_bf16 a[16:31], v[40:43], v[80:83], a[16:31]
    v_mfma_f32_32x32x16_bf16 a[0:15], v[28:31], v[84:87], a[0:15]
    v_mfma_f32_32x32x16_bf16 a[16:31], v[36:39], v[84:87], a[16:31]
    v_mfma_f32_32x32x16_bf16 a[0:15], v[24:27], v[88:91], a[0:15]
    v_mfma_f32_32x32x16_bf16 a[16:31], v[32:35], v[88:91], a[16:31]
    v_mfma_f32_32x32x16_bf16 a[0:15], v[20:23], v[92:95], a[0:15]
    v_mfma_f32_32x32x16_bf16 a[16:31], v[28:31], v[92:95], a[16:31]
    ds_read_b128 v[60:63], v4 offset:3008
    ds_read_b128 v[16:19], v4 offset:2976
    ds_read_b128 v[20:23], v4 offset:2944
    ds_read_b128 v[24:27], v4 offset:2912
    ds_read_b128 v[80:83], v5 offset:3168
    ds_read_b128 v[84:87], v5 offset:3200
    ds_read_b128 v[88:91], v5 offset:3232
    ds_read_b128 v[92:95], v5 offset:3264
    s_waitcnt lgkmcnt(8)
    v_mfma_f32_32x32x16_bf16 a[0:15], v[48:51], v[64:67], a[0:15]
    v_mfma_f32_32x32x16_bf16 a[16:31], v[56:59], v[64:67], a[16:31]
    v_mfma_f32_32x32x16_bf16 a[0:15], v[44:47], v[68:71], a[0:15]
    v_mfma_f32_32x32x16_bf16 a[16:31], v[52:55], v[68:71], a[16:31]
    v_mfma_f32_32x32x16_bf16 a[0:15], v[40:43], v[72:75], a[0:15]
    v_mfma_f32_32x32x16_bf16 a[16:31], v[48:51], v[72:75], a[16:31]
    v_mfma_f32_32x32x16_bf16 a[0:15], v[36:39], v[76:79], a[0:15]
    v_mfma_f32_32x32x16_bf16 a[16:31], v[44:47], v[76:79], a[16:31]
    ds_read_b128 v[28:31], v4 offset:2880
    ds_read_b128 v[32:35], v4 offset:2848
    ds_read_b128 v[36:39], v4 offset:2816
    ds_read_b128 v[40:43], v4 offset:2784
    ds_read_b128 v[64:67], v5 offset:3024
    ds_read_b128 v[68:71], v5 offset:3056
    ds_read_b128 v[72:75], v5 offset:3088
    ds_read_b128 v[76:79], v5 offset:3120
    s_waitcnt lgkmcnt(8)
    v_mfma_f32_32x32x16_bf16 a[0:15], v[16:19], v[80:83], a[0:15]
    v_mfma_f32_32x32x16_bf16 a[16:31], v[24:27], v[80:83], a[16:31]
    v_mfma_f32_32x32x16_bf16 a[0:15], v[60:63], v[84:87], a[0:15]
    v_mfma_f32_32x32x16_bf16 a[16:31], v[20:23], v[84:87], a[16:31]
    v_mfma_f32_32x32x16_bf16 a[0:15], v[56:59], v[88:91], a[0:15]
    v_mfma_f32_32x32x16_bf16 a[16:31], v[16:19], v[88:91], a[16:31]
    v_mfma_f32_32x32x16_bf16 a[0:15], v[52:55], v[92:95], a[0:15]
    v_mfma_f32_32x32x16_bf16 a[16:31], v[60:63], v[92:95], a[16:31]
    ds_read_b128 v[44:47], v4 offset:2752
    ds_read_b128 v[48:51], v4 offset:2720
    ds_read_b128 v[52:55], v4 offset:2688
    ds_read_b128 v[56:59], v4 offset:2656
    ds_read_b128 v[80:83], v5 offset:2880
    ds_read_b128 v[84:87], v5 offset:2912
    ds_read_b128 v[88:91], v5 offset:2944
    ds_read_b128 v[92:95], v5 offset:2976
    s_waitcnt lgkmcnt(8)
    v_mfma_f32_32x32x16_bf16 a[0:15], v[32:35], v[64:67], a[0:15]
    v_mfma_f32_32x32x16_bf16 a[16:31], v[40:43], v[64:67], a[16:31]
    v_mfma_f32_32x32x16_bf16 a[0:15], v[28:31], v[68:71], a[0:15]
    v_mfma_f32_32x32x16_bf16 a[16:31], v[36:39], v[68:71], a[16:31]
    v_mfma_f32_32x32x16_bf16 a[0:15], v[24:27], v[72:75], a[0:15]
    v_mfma_f32_32x32x16_bf16 a[16:31], v[32:35], v[72:75], a[16:31]
    v_mfma_f32_32x32x16_bf16 a[0:15], v[20:23], v[76:79], a[0:15]
    v_mfma_f32_32x32x16_bf16 a[16:31], v[28:31], v[76:79], a[16:31]
    ds_read_b128 v[60:63], v4 offset:2624
    ds_read_b128 v[16:19], v4 offset:2592
    ds_read_b128 v[20:23], v4 offset:2560
    ds_read_b128 v[24:27], v4 offset:2528
    ds_read_b128 v[64:67], v5 offset:2736
    ds_read_b128 v[68:71], v5 offset:2768
    ds_read_b128 v[72:75], v5 offset:2800
    ds_read_b128 v[76:79], v5 offset:2832
    s_waitcnt lgkmcnt(8)
    v_mfma_f32_32x32x16_bf16 a[0:15], v[48:51], v[80:83], a[0:15]
    v_mfma_f32_32x32x16_bf16 a[16:31], v[56:59], v[80:83], a[16:31]
    v_mfma_f32_32x32x16_bf16 a[0:15], v[44:47], v[84:87], a[0:15]
    v_mfma_f32_32x32x16_bf16 a[16:31], v[52:55], v[84:87], a[16:31]
    v_mfma_f32_32x32x16_bf16 a[0:15], v[40:43], v[88:91], a[0:15]
    v_mfma_f32_32x32x16_bf16 a[16:31], v[48:51], v[88:91], a[16:31]
    v_mfma_f32_32x32x16_bf16 a[0:15], v[36:39], v[92:95], a[0:15]
    v_mfma_f32_32x32x16_bf16 a[16:31], v[44:47], v[92:95], a[16:31]
    ds_read_b128 v[28:31], v4 offset:2496
    ds_read_b128 v[32:35], v4 offset:2464
    ds_read_b128 v[36:39], v4 offset:2432
    ds_read_b128 v[40:43], v4 offset:2400
    ds_read_b128 v[80:83], v5 offset:2592
    ds_read_b128 v[84:87], v5 offset:2624
    ds_read_b128 v[88:91], v5 offset:2656
    ds_read_b128 v[92:95], v5 offset:2688
    s_waitcnt lgkmcnt(8)
    v_mfma_f32_32x32x16_bf16 a[0:15], v[16:19], v[64:67], a[0:15]
    v_mfma_f32_32x32x16_bf16 a[16:31], v[24:27], v[64:67], a[16:31]
    v_mfma_f32_32x32x16_bf16 a[0:15], v[60:63], v[68:71], a[0:15]
    v_mfma_f32_32x32x16_bf16 a[16:31], v[20:23], v[68:71], a[16:31]
    v_mfma_f32_32x32x16_bf16 a[0:15], v[56:59], v[72:75], a[0:15]
    v_mfma_f32_32x32x16_bf16 a[16:31], v[16:19], v[72:75], a[16:31]
    v_mfma_f32_32x32x16_bf16 a[0:15], v[52:55], v[76:79], a[0:15]
    v_mfma_f32_32x32x16_bf16 a[16:31], v[60:63], v[76:79], a[16:31]
    ds_read_b128 v[44:47], v4 offset:2368
    ds_read_b128 v[48:51], v4 offset:2336
    ds_read_b128 v[52:55], v4 offset:2304
    ds_read_b128 v[56:59], v4 offset:2272
    ds_read_b128 v[64:67], v5 offset:2448
    ds_read_b128 v[68:71], v5 offset:2480
    ds_read_b128 v[72:75], v5 offset:2512
    ds_read_b128 v[76:79], v5 offset:2544
    s_waitcnt lgkmcnt(8)
    v_mfma_f32_32x32x16_bf16 a[0:15], v[32:35], v[80:83], a[0:15]
    v_mfma_f32_32x32x16_bf16 a[16:31], v[40:43], v[80:83], a[16:31]
    v_mfma_f32_32x32x16_bf16 a[0:15], v[28:31], v[84:87], a[0:15]
    v_mfma_f32_32x32x16_bf16 a[16:31], v[36:39], v[84:87], a[16:31]
    v_mfma_f32_32x32x16_bf16 a[0:15], v[24:27], v[88:91], a[0:15]
    v_mfma_f32_32x32x16_bf16 a[16:31], v[32:35], v[88:91], a[16:31]
    v_mfma_f32_32x32x16_bf16 a[0:15], v[20:23], v[92:95], a[0:15]
    v_mfma_f32_32x32x16_bf16 a[16:31], v[28:31], v[92:95], a[16:31]
    ds_read_b128 v[60:63], v4 offset:2240
    ds_read_b128 v[16:19], v4 offset:2208
    ds_read_b128 v[20:23], v4 offset:2176
    ds_read_b128 v[24:27], v4 offset:2144
    ds_read_b128 v[80:83], v5 offset:2304
    ds_read_b128 v[84:87], v5 offset:2336
    ds_read_b128 v[88:91], v5 offset:2368
    ds_read_b128 v[92:95], v5 offset:2400
    s_waitcnt lgkmcnt(8)
    v_mfma_f32_32x32x16_bf16 a[0:15], v[48:51], v[64:67], a[0:15]
    v_mfma_f32_32x32x16_bf16 a[16:31], v[56:59], v[64:67], a[16:31]
    v_mfma_f32_32x32x16_bf16 a[0:15], v[44:47], v[68:71], a[0:15]
    v_mfma_f32_32x32x16_bf16 a[16:31], v[52:55], v[68:71], a[16:31]
    v_mfma_f32_32x32x16_bf16 a[0:15], v[40:43], v[72:75], a[0:15]
    v_mfma_f32_32x32x16_bf16 a[16:31], v[48:51], v[72:75], a[16:31]
    v_mfma_f32_32x32x16_bf16 a[0:15], v[36:39], v[76:79], a[0:15]
    v_mfma_f32_32x32x16_bf16 a[16:31], v[44:47], v[76:79], a[16:31]
    s_waitcnt lgkmcnt(0)
    v_mfma_f32_32x32x16_bf16 a[0:15], v[16:19], v[80:83], a[0:15]
    v_mfma_f32_32x32x16_bf16 a[16:31], v[24:27], v[80:83], a[16:31]
    v_mfma_f32_32x32x16_bf16 a[0:15], v[60:63], v[84:87], a[0:15]
    v_mfma_f32_32x32x16_bf16 a[16:31], v[20:23], v[84:87], a[16:31]
    v_mfma_f32_32x32x16_bf16 a[0:15], v[56:59], v[88:91], a[0:15]
    v_mfma_f32_32x32x16_bf16 a[16:31], v[16:19], v[88:91], a[16:31]
    v_mfma_f32_32x32x16_bf16 a[0:15], v[52:55], v[92:95], a[0:15]
    v_mfma_f32_32x32x16_bf16 a[16:31], v[60:63], v[92:95], a[16:31]
    s_nop 15
    s_barrier

    v_lshlrev_b32 v8, 4, v0
    v_lshrrev_b32 v9, 6, v0
    v_mul_u32_u24 v9, 3072, v9
    v_add_u32 v8, v8, v9
    v_xor_b32 v9, 4096, v8
    s_cmp_eq_u32 s21, 0
    s_cbranch_scc1 K2_HW0

    v_accvgpr_read_b32 v16, a0
    v_accvgpr_read_b32 v17, a1
    v_accvgpr_read_b32 v18, a2
    v_accvgpr_read_b32 v19, a3
    v_accvgpr_read_b32 v20, a4
    v_accvgpr_read_b32 v21, a5
    v_accvgpr_read_b32 v22, a6
    v_accvgpr_read_b32 v23, a7
    v_accvgpr_read_b32 v24, a8
    v_accvgpr_read_b32 v25, a9
    v_accvgpr_read_b32 v26, a10
    v_accvgpr_read_b32 v27, a11
    v_accvgpr_read_b32 v28, a12
    v_accvgpr_read_b32 v29, a13
    v_accvgpr_read_b32 v30, a14
    v_accvgpr_read_b32 v31, a15
    v_accvgpr_read_b32 v32, a16
    v_accvgpr_read_b32 v33, a17
    v_accvgpr_read_b32 v34, a18
    v_accvgpr_read_b32 v35, a19
    v_accvgpr_read_b32 v36, a20
    v_accvgpr_read_b32 v37, a21
    v_accvgpr_read_b32 v38, a22
    v_accvgpr_read_b32 v39, a23
    v_accvgpr_read_b32 v40, a24
    v_accvgpr_read_b32 v41, a25
    v_accvgpr_read_b32 v42, a26
    v_accvgpr_read_b32 v43, a27
    v_accvgpr_read_b32 v44, a28
    v_accvgpr_read_b32 v45, a29
    v_accvgpr_read_b32 v46, a30
    v_accvgpr_read_b32 v47, a31
    s_branch K2_SEND
K2_HW0:
    v_accvgpr_read_b32 v16, a16
    v_accvgpr_read_b32 v17, a17
    v_accvgpr_read_b32 v18, a18
    v_accvgpr_read_b32 v19, a19
    v_accvgpr_read_b32 v20, a20
    v_accvgpr_read_b32 v21, a21
    v_accvgpr_read_b32 v22, a22
    v_accvgpr_read_b32 v23, a23
    v_accvgpr_read_b32 v24, a24
    v_accvgpr_read_b32 v25, a25
    v_accvgpr_read_b32 v26, a26
    v_accvgpr_read_b32 v27, a27
    v_accvgpr_read_b32 v28, a28
    v_accvgpr_read_b32 v29, a29
    v_accvgpr_read_b32 v30, a30
    v_accvgpr_read_b32 v31, a31
    v_accvgpr_read_b32 v32, a0
    v_accvgpr_read_b32 v33, a1
    v_accvgpr_read_b32 v34, a2
    v_accvgpr_read_b32 v35, a3
    v_accvgpr_read_b32 v36, a4
    v_accvgpr_read_b32 v37, a5
    v_accvgpr_read_b32 v38, a6
    v_accvgpr_read_b32 v39, a7
    v_accvgpr_read_b32 v40, a8
    v_accvgpr_read_b32 v41, a9
    v_accvgpr_read_b32 v42, a10
    v_accvgpr_read_b32 v43, a11
    v_accvgpr_read_b32 v44, a12
    v_accvgpr_read_b32 v45, a13
    v_accvgpr_read_b32 v46, a14
    v_accvgpr_read_b32 v47, a15
K2_SEND:
    ds_write_b128 v8, v[16:19] offset:0
    ds_write_b128 v8, v[20:23] offset:1024
    ds_write_b128 v8, v[24:27] offset:2048
    ds_write_b128 v8, v[28:31] offset:3072
    s_waitcnt lgkmcnt(0)
    s_barrier
    ds_read_b128 v[48:51], v9 offset:0
    ds_read_b128 v[52:55], v9 offset:1024
    ds_read_b128 v[56:59], v9 offset:2048
    ds_read_b128 v[60:63], v9 offset:3072
    s_waitcnt lgkmcnt(0)
    v_add_f32 v32, v32, v48
    v_add_f32 v33, v33, v49
    v_add_f32 v34, v34, v50
    v_add_f32 v35, v35, v51
    v_add_f32 v36, v36, v52
    v_add_f32 v37, v37, v53
    v_add_f32 v38, v38, v54
    v_add_f32 v39, v39, v55
    v_add_f32 v40, v40, v56
    v_add_f32 v41, v41, v57
    v_add_f32 v42, v42, v58
    v_add_f32 v43, v43, v59
    v_add_f32 v44, v44, v60
    v_add_f32 v45, v45, v61
    v_add_f32 v46, v46, v62
    v_add_f32 v47, v47, v63
    v_cvt_pk_bf16_f32 v16, v32, v33
    v_cvt_pk_bf16_f32 v17, v34, v35
    v_cvt_pk_bf16_f32 v18, v36, v37
    v_cvt_pk_bf16_f32 v19, v38, v39
    v_cvt_pk_bf16_f32 v20, v40, v41
    v_cvt_pk_bf16_f32 v21, v42, v43
    v_cvt_pk_bf16_f32 v22, v44, v45
    v_cvt_pk_bf16_f32 v23, v46, v47
    s_add_u32 s10, s6, 2097152
    s_addc_u32 s11, s7, 0

    s_mov_b32 s16, s10
    s_and_b32 s17, s11, 0xffff
    s_mov_b32 s18, 2097152
    s_mov_b32 s19, 0x00020000

    v_lshlrev_b32 v6, 7, v1
    v_lshlrev_b32 v7, 3, v2
    v_add_u32 v6, v6, v7
    s_lshl_b32 s30, s21, 6
    s_add_u32 s30, s30, s25
    v_add_u32 v6, s30, v6

    buffer_store_dwordx2 v[16:17], v6, s[16:19], 0 offen offset:0
    buffer_store_dwordx2 v[18:19], v6, s[16:19], 0 offen offset:16
    buffer_store_dwordx2 v[20:21], v6, s[16:19], 0 offen offset:32
    buffer_store_dwordx2 v[22:23], v6, s[16:19], 0 offen offset:48
K2_END:
    s_endpgm
.globl k3_kernel
.p2align 8
.type k3_kernel,@function
k3_kernel:
    s_cmp_ge_u32 s2, 256
    s_cbranch_scc1 K3_END
    s_load_dwordx2 s[4:5], s[0:1], 0
    s_load_dwordx2 s[6:7], s[0:1], 40
    s_load_dwordx2 s[8:9], s[0:1], 96
    v_lshrrev_b32 v8, 6, v0
    v_lshlrev_b32 v8, 5, v8
    v_mov_b32 v9, 0
    s_mov_b32 s42, 0
    s_mov_b32 s43, 0x80000000
    v_lshlrev_b32 v1, 2, v0
    s_lshl_b32 s3, s2, 13
    v_add_u32 v2, s3, v1
    v_add_u32 v3, 4096, v2
    v_lshlrev_b32 v4, 13, v0
    s_lshl_b32 s10, s2, 4
    v_add_u32 v4, s10, v4
    v_add_u32 v5, 4096, v4
    s_waitcnt lgkmcnt(0)

    s_mov_b32 s12, s4
    s_and_b32 s13, s5, 0xffff
    s_mov_b32 s14, 2097152
    s_mov_b32 s15, 0x00020000

    s_mov_b32 s16, s6
    s_and_b32 s17, s7, 0xffff
    s_mov_b32 s18, 1024
    s_mov_b32 s19, 0x00020000

    s_mov_b32 s20, s8
    s_and_b32 s21, s9, 0xffff
    s_mov_b32 s22, 8388608
    s_mov_b32 s23, 0x00020000

    buffer_load_dword v16, v2, s[12:15], 0 offen offset:0
    buffer_load_dword v17, v2, s[12:15], 0 offen offset:1024
    buffer_load_dword v18, v2, s[12:15], 0 offen offset:2048
    buffer_load_dword v19, v2, s[12:15], 0 offen offset:3072
    buffer_load_dword v20, v3, s[12:15], 0 offen offset:0
    buffer_load_dword v21, v3, s[12:15], 0 offen offset:1024
    buffer_load_dword v22, v3, s[12:15], 0 offen offset:2048
    buffer_load_dword v23, v3, s[12:15], 0 offen offset:3072
    s_mov_b32 s24, 2097152
    buffer_load_dwordx4 v[24:27], v4, s[20:23], 0 offen
    buffer_load_dwordx4 v[28:31], v5, s[20:23], 0 offen
    buffer_load_dwordx4 v[32:35], v4, s[20:23], s24 offen
    buffer_load_dwordx4 v[36:39], v5, s[20:23], s24 offen
    buffer_load_dword v40, v1, s[16:19], 0 offen
    s_waitcnt vmcnt(0)

    v_lshlrev_b32 v44, 16, v16
    v_and_b32 v52, 0xffff0000, v16
    v_lshlrev_b32 v45, 16, v17
    v_and_b32 v53, 0xffff0000, v17
    v_lshlrev_b32 v46, 16, v18
    v_and_b32 v54, 0xffff0000, v18
    v_lshlrev_b32 v47, 16, v19
    v_and_b32 v55, 0xffff0000, v19
    v_lshlrev_b32 v48, 16, v20
    v_and_b32 v56, 0xffff0000, v20
    v_lshlrev_b32 v49, 16, v21
    v_and_b32 v57, 0xffff0000, v21
    v_lshlrev_b32 v50, 16, v22
    v_and_b32 v58, 0xffff0000, v22
    v_lshlrev_b32 v51, 16, v23
    v_and_b32 v59, 0xffff0000, v23
    v_add_f32 v64, v44, v52
    v_add_f32 v65, v45, v53
    v_add_f32 v66, v46, v54
    v_add_f32 v67, v47, v55
    v_add_f32 v68, v48, v56
    v_add_f32 v69, v49, v57
    v_add_f32 v70, v50, v58
    v_add_f32 v71, v51, v59
    v_add_f32_dpp v64, v64, v64 quad_perm:[1,0,3,2] row_mask:0xf bank_mask:0xf
    v_add_f32_dpp v65, v65, v65 quad_perm:[1,0,3,2] row_mask:0xf bank_mask:0xf
    v_add_f32_dpp v66, v66, v66 quad_perm:[1,0,3,2] row_mask:0xf bank_mask:0xf
    v_add_f32_dpp v67, v67, v67 quad_perm:[1,0,3,2] row_mask:0xf bank_mask:0xf
    v_add_f32_dpp v68, v68, v68 quad_perm:[1,0,3,2] row_mask:0xf bank_mask:0xf
    v_add_f32_dpp v69, v69, v69 quad_perm:[1,0,3,2] row_mask:0xf bank_mask:0xf
    v_add_f32_dpp v70, v70, v70 quad_perm:[1,0,3,2] row_mask:0xf bank_mask:0xf
    v_add_f32_dpp v71, v71, v71 quad_perm:[1,0,3,2] row_mask:0xf bank_mask:0xf
    v_add_f32_dpp v64, v64, v64 quad_perm:[2,3,0,1] row_mask:0xf bank_mask:0xf
    v_add_f32_dpp v65, v65, v65 quad_perm:[2,3,0,1] row_mask:0xf bank_mask:0xf
    v_add_f32_dpp v66, v66, v66 quad_perm:[2,3,0,1] row_mask:0xf bank_mask:0xf
    v_add_f32_dpp v67, v67, v67 quad_perm:[2,3,0,1] row_mask:0xf bank_mask:0xf
    v_add_f32_dpp v68, v68, v68 quad_perm:[2,3,0,1] row_mask:0xf bank_mask:0xf
    v_add_f32_dpp v69, v69, v69 quad_perm:[2,3,0,1] row_mask:0xf bank_mask:0xf
    v_add_f32_dpp v70, v70, v70 quad_perm:[2,3,0,1] row_mask:0xf bank_mask:0xf
    v_add_f32_dpp v71, v71, v71 quad_perm:[2,3,0,1] row_mask:0xf bank_mask:0xf
    v_add_f32_dpp v64, v64, v64 row_half_mirror row_mask:0xf bank_mask:0xf
    v_add_f32_dpp v65, v65, v65 row_half_mirror row_mask:0xf bank_mask:0xf
    v_add_f32_dpp v66, v66, v66 row_half_mirror row_mask:0xf bank_mask:0xf
    v_add_f32_dpp v67, v67, v67 row_half_mirror row_mask:0xf bank_mask:0xf
    v_add_f32_dpp v68, v68, v68 row_half_mirror row_mask:0xf bank_mask:0xf
    v_add_f32_dpp v69, v69, v69 row_half_mirror row_mask:0xf bank_mask:0xf
    v_add_f32_dpp v70, v70, v70 row_half_mirror row_mask:0xf bank_mask:0xf
    v_add_f32_dpp v71, v71, v71 row_half_mirror row_mask:0xf bank_mask:0xf
    v_add_f32_dpp v64, v64, v64 row_mirror row_mask:0xf bank_mask:0xf
    v_add_f32_dpp v65, v65, v65 row_mirror row_mask:0xf bank_mask:0xf
    v_add_f32_dpp v66, v66, v66 row_mirror row_mask:0xf bank_mask:0xf
    v_add_f32_dpp v67, v67, v67 row_mirror row_mask:0xf bank_mask:0xf
    v_add_f32_dpp v68, v68, v68 row_mirror row_mask:0xf bank_mask:0xf
    v_add_f32_dpp v69, v69, v69 row_mirror row_mask:0xf bank_mask:0xf
    v_add_f32_dpp v70, v70, v70 row_mirror row_mask:0xf bank_mask:0xf
    v_add_f32_dpp v71, v71, v71 row_mirror row_mask:0xf bank_mask:0xf
    v_add_f32_dpp v64, v64, v64 row_bcast:15 row_mask:0xa bank_mask:0xf
    v_add_f32_dpp v65, v65, v65 row_bcast:15 row_mask:0xa bank_mask:0xf
    v_add_f32_dpp v66, v66, v66 row_bcast:15 row_mask:0xa bank_mask:0xf
    v_add_f32_dpp v67, v67, v67 row_bcast:15 row_mask:0xa bank_mask:0xf
    v_add_f32_dpp v68, v68, v68 row_bcast:15 row_mask:0xa bank_mask:0xf
    v_add_f32_dpp v69, v69, v69 row_bcast:15 row_mask:0xa bank_mask:0xf
    v_add_f32_dpp v70, v70, v70 row_bcast:15 row_mask:0xa bank_mask:0xf
    v_add_f32_dpp v71, v71, v71 row_bcast:15 row_mask:0xa bank_mask:0xf
    v_add_f32_dpp v64, v64, v64 row_bcast:31 row_mask:0xc bank_mask:0xf
    v_add_f32_dpp v65, v65, v65 row_bcast:31 row_mask:0xc bank_mask:0xf
    v_add_f32_dpp v66, v66, v66 row_bcast:31 row_mask:0xc bank_mask:0xf
    v_add_f32_dpp v67, v67, v67 row_bcast:31 row_mask:0xc bank_mask:0xf
    v_add_f32_dpp v68, v68, v68 row_bcast:31 row_mask:0xc bank_mask:0xf
    v_add_f32_dpp v69, v69, v69 row_bcast:31 row_mask:0xc bank_mask:0xf
    v_add_f32_dpp v70, v70, v70 row_bcast:31 row_mask:0xc bank_mask:0xf
    v_add_f32_dpp v71, v71, v71 row_bcast:31 row_mask:0xc bank_mask:0xf
    s_nop 1
    s_mov_b64 s[40:41], exec
    s_mov_b64 exec, s[42:43]
    ds_write_b128 v8, v[64:67] offset:0
    ds_write_b128 v8, v[68:71] offset:16
    s_mov_b64 exec, s[40:41]
    s_waitcnt lgkmcnt(0)
    s_barrier

    ds_read_b128 v[100:103], v9 offset:0
    ds_read_b128 v[104:107], v9 offset:16
    ds_read_b128 v[108:111], v9 offset:32
    ds_read_b128 v[112:115], v9 offset:48
    ds_read_b128 v[116:119], v9 offset:64
    ds_read_b128 v[120:123], v9 offset:80
    ds_read_b128 v[124:127], v9 offset:96
    ds_read_b128 v[128:131], v9 offset:112
    s_waitcnt lgkmcnt(0)
    v_add_f32 v72, v100, v108
    v_add_f32 v116, v116, v124
    v_add_f32 v73, v101, v109
    v_add_f32 v117, v117, v125
    v_add_f32 v74, v102, v110
    v_add_f32 v118, v118, v126
    v_add_f32 v75, v103, v111
    v_add_f32 v119, v119, v127
    v_add_f32 v76, v104, v112
    v_add_f32 v120, v120, v128
    v_add_f32 v77, v105, v113
    v_add_f32 v121, v121, v129
    v_add_f32 v78, v106, v114
    v_add_f32 v122, v122, v130
    v_add_f32 v79, v107, v115
    v_add_f32 v123, v123, v131
    v_add_f32 v72, v72, v116
    v_add_f32 v73, v73, v117
    v_add_f32 v74, v74, v118
    v_add_f32 v75, v75, v119
    v_add_f32 v76, v76, v120
    v_add_f32 v77, v77, v121
    v_add_f32 v78, v78, v122
    v_add_f32 v79, v79, v123
    v_mul_f32 v72, 0x3b000000, v72
    v_mul_f32 v73, 0x3b000000, v73
    v_mul_f32 v74, 0x3b000000, v74
    v_mul_f32 v75, 0x3b000000, v75
    v_mul_f32 v76, 0x3b000000, v76
    v_mul_f32 v77, 0x3b000000, v77
    v_mul_f32 v78, 0x3b000000, v78
    v_mul_f32 v79, 0x3b000000, v79
    v_sub_f32 v80, v44, v72
    v_sub_f32 v81, v52, v72
    v_mul_f32 v80, v80, v80
    v_fma_f32 v64, v81, v81, v80
    v_sub_f32 v80, v45, v73
    v_sub_f32 v81, v53, v73
    v_mul_f32 v80, v80, v80
    v_fma_f32 v65, v81, v81, v80
    v_sub_f32 v80, v46, v74
    v_sub_f32 v81, v54, v74
    v_mul_f32 v80, v80, v80
    v_fma_f32 v66, v81, v81, v80
    v_sub_f32 v80, v47, v75
    v_sub_f32 v81, v55, v75
    v_mul_f32 v80, v80, v80
    v_fma_f32 v67, v81, v81, v80
    v_sub_f32 v80, v48, v76
    v_sub_f32 v81, v56, v76
    v_mul_f32 v80, v80, v80
    v_fma_f32 v68, v81, v81, v80
    v_sub_f32 v80, v49, v77
    v_sub_f32 v81, v57, v77
    v_mul_f32 v80, v80, v80
    v_fma_f32 v69, v81, v81, v80
    v_sub_f32 v80, v50, v78
    v_sub_f32 v81, v58, v78
    v_mul_f32 v80, v80, v80
    v_fma_f32 v70, v81, v81, v80
    v_sub_f32 v80, v51, v79
    v_sub_f32 v81, v59, v79
    v_mul_f32 v80, v80, v80
    v_fma_f32 v71, v81, v81, v80
    v_add_f32_dpp v64, v64, v64 quad_perm:[1,0,3,2] row_mask:0xf bank_mask:0xf
    v_add_f32_dpp v65, v65, v65 quad_perm:[1,0,3,2] row_mask:0xf bank_mask:0xf
    v_add_f32_dpp v66, v66, v66 quad_perm:[1,0,3,2] row_mask:0xf bank_mask:0xf
    v_add_f32_dpp v67, v67, v67 quad_perm:[1,0,3,2] row_mask:0xf bank_mask:0xf
    v_add_f32_dpp v68, v68, v68 quad_perm:[1,0,3,2] row_mask:0xf bank_mask:0xf
    v_add_f32_dpp v69, v69, v69 quad_perm:[1,0,3,2] row_mask:0xf bank_mask:0xf
    v_add_f32_dpp v70, v70, v70 quad_perm:[1,0,3,2] row_mask:0xf bank_mask:0xf
    v_add_f32_dpp v71, v71, v71 quad_perm:[1,0,3,2] row_mask:0xf bank_mask:0xf
    v_add_f32_dpp v64, v64, v64 quad_perm:[2,3,0,1] row_mask:0xf bank_mask:0xf
    v_add_f32_dpp v65, v65, v65 quad_perm:[2,3,0,1] row_mask:0xf bank_mask:0xf
    v_add_f32_dpp v66, v66, v66 quad_perm:[2,3,0,1] row_mask:0xf bank_mask:0xf
    v_add_f32_dpp v67, v67, v67 quad_perm:[2,3,0,1] row_mask:0xf bank_mask:0xf
    v_add_f32_dpp v68, v68, v68 quad_perm:[2,3,0,1] row_mask:0xf bank_mask:0xf
    v_add_f32_dpp v69, v69, v69 quad_perm:[2,3,0,1] row_mask:0xf bank_mask:0xf
    v_add_f32_dpp v70, v70, v70 quad_perm:[2,3,0,1] row_mask:0xf bank_mask:0xf
    v_add_f32_dpp v71, v71, v71 quad_perm:[2,3,0,1] row_mask:0xf bank_mask:0xf
    v_add_f32_dpp v64, v64, v64 row_half_mirror row_mask:0xf bank_mask:0xf
    v_add_f32_dpp v65, v65, v65 row_half_mirror row_mask:0xf bank_mask:0xf
    v_add_f32_dpp v66, v66, v66 row_half_mirror row_mask:0xf bank_mask:0xf
    v_add_f32_dpp v67, v67, v67 row_half_mirror row_mask:0xf bank_mask:0xf
    v_add_f32_dpp v68, v68, v68 row_half_mirror row_mask:0xf bank_mask:0xf
    v_add_f32_dpp v69, v69, v69 row_half_mirror row_mask:0xf bank_mask:0xf
    v_add_f32_dpp v70, v70, v70 row_half_mirror row_mask:0xf bank_mask:0xf
    v_add_f32_dpp v71, v71, v71 row_half_mirror row_mask:0xf bank_mask:0xf
    v_add_f32_dpp v64, v64, v64 row_mirror row_mask:0xf bank_mask:0xf
    v_add_f32_dpp v65, v65, v65 row_mirror row_mask:0xf bank_mask:0xf
    v_add_f32_dpp v66, v66, v66 row_mirror row_mask:0xf bank_mask:0xf
    v_add_f32_dpp v67, v67, v67 row_mirror row_mask:0xf bank_mask:0xf
    v_add_f32_dpp v68, v68, v68 row_mirror row_mask:0xf bank_mask:0xf
    v_add_f32_dpp v69, v69, v69 row_mirror row_mask:0xf bank_mask:0xf
    v_add_f32_dpp v70, v70, v70 row_mirror row_mask:0xf bank_mask:0xf
    v_add_f32_dpp v71, v71, v71 row_mirror row_mask:0xf bank_mask:0xf
    v_add_f32_dpp v64, v64, v64 row_bcast:15 row_mask:0xa bank_mask:0xf
    v_add_f32_dpp v65, v65, v65 row_bcast:15 row_mask:0xa bank_mask:0xf
    v_add_f32_dpp v66, v66, v66 row_bcast:15 row_mask:0xa bank_mask:0xf
    v_add_f32_dpp v67, v67, v67 row_bcast:15 row_mask:0xa bank_mask:0xf
    v_add_f32_dpp v68, v68, v68 row_bcast:15 row_mask:0xa bank_mask:0xf
    v_add_f32_dpp v69, v69, v69 row_bcast:15 row_mask:0xa bank_mask:0xf
    v_add_f32_dpp v70, v70, v70 row_bcast:15 row_mask:0xa bank_mask:0xf
    v_add_f32_dpp v71, v71, v71 row_bcast:15 row_mask:0xa bank_mask:0xf
    v_add_f32_dpp v64, v64, v64 row_bcast:31 row_mask:0xc bank_mask:0xf
    v_add_f32_dpp v65, v65, v65 row_bcast:31 row_mask:0xc bank_mask:0xf
    v_add_f32_dpp v66, v66, v66 row_bcast:31 row_mask:0xc bank_mask:0xf
    v_add_f32_dpp v67, v67, v67 row_bcast:31 row_mask:0xc bank_mask:0xf
    v_add_f32_dpp v68, v68, v68 row_bcast:31 row_mask:0xc bank_mask:0xf
    v_add_f32_dpp v69, v69, v69 row_bcast:31 row_mask:0xc bank_mask:0xf
    v_add_f32_dpp v70, v70, v70 row_bcast:31 row_mask:0xc bank_mask:0xf
    v_add_f32_dpp v71, v71, v71 row_bcast:31 row_mask:0xc bank_mask:0xf
    s_nop 1
    s_mov_b64 s[40:41], exec
    s_mov_b64 exec, s[42:43]
    ds_write_b128 v8, v[64:67] offset:128
    ds_write_b128 v8, v[68:71] offset:144
    s_mov_b64 exec, s[40:41]
    s_waitcnt lgkmcnt(0)
    s_barrier

    ds_read_b128 v[100:103], v9 offset:128
    ds_read_b128 v[104:107], v9 offset:144
    ds_read_b128 v[108:111], v9 offset:160
    ds_read_b128 v[112:115], v9 offset:176
    ds_read_b128 v[116:119], v9 offset:192
    ds_read_b128 v[120:123], v9 offset:208
    ds_read_b128 v[124:127], v9 offset:224
    ds_read_b128 v[128:131], v9 offset:240
    s_waitcnt lgkmcnt(0)
    v_add_f32 v80, v100, v108
    v_add_f32 v116, v116, v124
    v_add_f32 v81, v101, v109
    v_add_f32 v117, v117, v125
    v_add_f32 v82, v102, v110
    v_add_f32 v118, v118, v126
    v_add_f32 v83, v103, v111
    v_add_f32 v119, v119, v127
    v_add_f32 v84, v104, v112
    v_add_f32 v120, v120, v128
    v_add_f32 v85, v105, v113
    v_add_f32 v121, v121, v129
    v_add_f32 v86, v106, v114
    v_add_f32 v122, v122, v130
    v_add_f32 v87, v107, v115
    v_add_f32 v123, v123, v131
    v_add_f32 v80, v80, v116
    v_add_f32 v81, v81, v117
    v_add_f32 v82, v82, v118
    v_add_f32 v83, v83, v119
    v_add_f32 v84, v84, v120
    v_add_f32 v85, v85, v121
    v_add_f32 v86, v86, v122
    v_add_f32 v87, v87, v123
    v_mul_f32 v80, 0x3b000000, v80
    v_cvt_pk_bf16_f32 v80, v80, v80
    v_lshlrev_b32 v80, 16, v80
    v_add_f32 v80, 0x3727c5ac, v80
    v_cvt_pk_bf16_f32 v80, v80, v80
    v_lshlrev_b32 v80, 16, v80
    v_sqrt_f32 v80, v80
    s_nop 0
    v_cvt_pk_bf16_f32 v80, v80, v80
    v_lshlrev_b32 v80, 16, v80
    v_cvt_pk_bf16_f32 v72, v72, v72
    v_lshlrev_b32 v72, 16, v72
    v_rcp_f32 v88, v80
    s_nop 0
    v_sub_f32 v89, v44, v72
    v_cvt_pk_bf16_f32 v89, v89, v89
    v_lshlrev_b32 v89, 16, v89
    v_mul_f32 v90, v89, v88
    v_fma_f32 v91, -v90, v80, v89
    v_fma_f32 v132, v91, v88, v90
    v_cvt_pk_bf16_f32 v132, v132, v132
    v_lshlrev_b32 v132, 16, v132
    v_sub_f32 v89, v52, v72
    v_cvt_pk_bf16_f32 v89, v89, v89
    v_lshlrev_b32 v89, 16, v89
    v_mul_f32 v90, v89, v88
    v_fma_f32 v91, -v90, v80, v89
    v_fma_f32 v140, v91, v88, v90
    v_cvt_pk_bf16_f32 v140, v140, v140
    v_lshlrev_b32 v140, 16, v140
    v_mul_f32 v81, 0x3b000000, v81
    v_cvt_pk_bf16_f32 v81, v81, v81
    v_lshlrev_b32 v81, 16, v81
    v_add_f32 v81, 0x3727c5ac, v81
    v_cvt_pk_bf16_f32 v81, v81, v81
    v_lshlrev_b32 v81, 16, v81
    v_sqrt_f32 v81, v81
    s_nop 0
    v_cvt_pk_bf16_f32 v81, v81, v81
    v_lshlrev_b32 v81, 16, v81
    v_cvt_pk_bf16_f32 v73, v73, v73
    v_lshlrev_b32 v73, 16, v73
    v_rcp_f32 v88, v81
    s_nop 0
    v_sub_f32 v89, v45, v73
    v_cvt_pk_bf16_f32 v89, v89, v89
    v_lshlrev_b32 v89, 16, v89
    v_mul_f32 v90, v89, v88
    v_fma_f32 v91, -v90, v81, v89
    v_fma_f32 v133, v91, v88, v90
    v_cvt_pk_bf16_f32 v133, v133, v133
    v_lshlrev_b32 v133, 16, v133
    v_sub_f32 v89, v53, v73
    v_cvt_pk_bf16_f32 v89, v89, v89
    v_lshlrev_b32 v89, 16, v89
    v_mul_f32 v90, v89, v88
    v_fma_f32 v91, -v90, v81, v89
    v_fma_f32 v141, v91, v88, v90
    v_cvt_pk_bf16_f32 v141, v141, v141
    v_lshlrev_b32 v141, 16, v141
    v_mul_f32 v82, 0x3b000000, v82
    v_cvt_pk_bf16_f32 v82, v82, v82
    v_lshlrev_b32 v82, 16, v82
    v_add_f32 v82, 0x3727c5ac, v82
    v_cvt_pk_bf16_f32 v82, v82, v82
    v_lshlrev_b32 v82, 16, v82
    v_sqrt_f32 v82, v82
    s_nop 0
    v_cvt_pk_bf16_f32 v82, v82, v82
    v_lshlrev_b32 v82, 16, v82
    v_cvt_pk_bf16_f32 v74, v74, v74
    v_lshlrev_b32 v74, 16, v74
    v_rcp_f32 v88, v82
    s_nop 0
    v_sub_f32 v89, v46, v74
    v_cvt_pk_bf16_f32 v89, v89, v89
    v_lshlrev_b32 v89, 16, v89
    v_mul_f32 v90, v89, v88
    v_fma_f32 v91, -v90, v82, v89
    v_fma_f32 v134, v91, v88, v90
    v_cvt_pk_bf16_f32 v134, v134, v134
    v_lshlrev_b32 v134, 16, v134
    v_sub_f32 v89, v54, v74
    v_cvt_pk_bf16_f32 v89, v89, v89
    v_lshlrev_b32 v89, 16, v89
    v_mul_f32 v90, v89, v88
    v_fma_f32 v91, -v90, v82, v89
    v_fma_f32 v142, v91, v88, v90
    v_cvt_pk_bf16_f32 v142, v142, v142
    v_lshlrev_b32 v142, 16, v142
    v_mul_f32 v83, 0x3b000000, v83
    v_cvt_pk_bf16_f32 v83, v83, v83
    v_lshlrev_b32 v83, 16, v83
    v_add_f32 v83, 0x3727c5ac, v83
    v_cvt_pk_bf16_f32 v83, v83, v83
    v_lshlrev_b32 v83, 16, v83
    v_sqrt_f32 v83, v83
    s_nop 0
    v_cvt_pk_bf16_f32 v83, v83, v83
    v_lshlrev_b32 v83, 16, v83
    v_cvt_pk_bf16_f32 v75, v75, v75
    v_lshlrev_b32 v75, 16, v75
    v_rcp_f32 v88, v83
    s_nop 0
    v_sub_f32 v89, v47, v75
    v_cvt_pk_bf16_f32 v89, v89, v89
    v_lshlrev_b32 v89, 16, v89
    v_mul_f32 v90, v89, v88
    v_fma_f32 v91, -v90, v83, v89
    v_fma_f32 v135, v91, v88, v90
    v_cvt_pk_bf16_f32 v135, v135, v135
    v_lshlrev_b32 v135, 16, v135
    v_sub_f32 v89, v55, v75
    v_cvt_pk_bf16_f32 v89, v89, v89
    v_lshlrev_b32 v89, 16, v89
    v_mul_f32 v90, v89, v88
    v_fma_f32 v91, -v90, v83, v89
    v_fma_f32 v143, v91, v88, v90
    v_cvt_pk_bf16_f32 v143, v143, v143
    v_lshlrev_b32 v143, 16, v143
    v_mul_f32 v84, 0x3b000000, v84
    v_cvt_pk_bf16_f32 v84, v84, v84
    v_lshlrev_b32 v84, 16, v84
    v_add_f32 v84, 0x3727c5ac, v84
    v_cvt_pk_bf16_f32 v84, v84, v84
    v_lshlrev_b32 v84, 16, v84
    v_sqrt_f32 v84, v84
    s_nop 0
    v_cvt_pk_bf16_f32 v84, v84, v84
    v_lshlrev_b32 v84, 16, v84
    v_cvt_pk_bf16_f32 v76, v76, v76
    v_lshlrev_b32 v76, 16, v76
    v_rcp_f32 v88, v84
    s_nop 0
    v_sub_f32 v89, v48, v76
    v_cvt_pk_bf16_f32 v89, v89, v89
    v_lshlrev_b32 v89, 16, v89
    v_mul_f32 v90, v89, v88
    v_fma_f32 v91, -v90, v84, v89
    v_fma_f32 v136, v91, v88, v90
    v_cvt_pk_bf16_f32 v136, v136, v136
    v_lshlrev_b32 v136, 16, v136
    v_sub_f32 v89, v56, v76
    v_cvt_pk_bf16_f32 v89, v89, v89
    v_lshlrev_b32 v89, 16, v89
    v_mul_f32 v90, v89, v88
    v_fma_f32 v91, -v90, v84, v89
    v_fma_f32 v144, v91, v88, v90
    v_cvt_pk_bf16_f32 v144, v144, v144
    v_lshlrev_b32 v144, 16, v144
    v_mul_f32 v85, 0x3b000000, v85
    v_cvt_pk_bf16_f32 v85, v85, v85
    v_lshlrev_b32 v85, 16, v85
    v_add_f32 v85, 0x3727c5ac, v85
    v_cvt_pk_bf16_f32 v85, v85, v85
    v_lshlrev_b32 v85, 16, v85
    v_sqrt_f32 v85, v85
    s_nop 0
    v_cvt_pk_bf16_f32 v85, v85, v85
    v_lshlrev_b32 v85, 16, v85
    v_cvt_pk_bf16_f32 v77, v77, v77
    v_lshlrev_b32 v77, 16, v77
    v_rcp_f32 v88, v85
    s_nop 0
    v_sub_f32 v89, v49, v77
    v_cvt_pk_bf16_f32 v89, v89, v89
    v_lshlrev_b32 v89, 16, v89
    v_mul_f32 v90, v89, v88
    v_fma_f32 v91, -v90, v85, v89
    v_fma_f32 v137, v91, v88, v90
    v_cvt_pk_bf16_f32 v137, v137, v137
    v_lshlrev_b32 v137, 16, v137
    v_sub_f32 v89, v57, v77
    v_cvt_pk_bf16_f32 v89, v89, v89
    v_lshlrev_b32 v89, 16, v89
    v_mul_f32 v90, v89, v88
    v_fma_f32 v91, -v90, v85, v89
    v_fma_f32 v145, v91, v88, v90
    v_cvt_pk_bf16_f32 v145, v145, v145
    v_lshlrev_b32 v145, 16, v145
    v_mul_f32 v86, 0x3b000000, v86
    v_cvt_pk_bf16_f32 v86, v86, v86
    v_lshlrev_b32 v86, 16, v86
    v_add_f32 v86, 0x3727c5ac, v86
    v_cvt_pk_bf16_f32 v86, v86, v86
    v_lshlrev_b32 v86, 16, v86
    v_sqrt_f32 v86, v86
    s_nop 0
    v_cvt_pk_bf16_f32 v86, v86, v86
    v_lshlrev_b32 v86, 16, v86
    v_cvt_pk_bf16_f32 v78, v78, v78
    v_lshlrev_b32 v78, 16, v78
    v_rcp_f32 v88, v86
    s_nop 0
    v_sub_f32 v89, v50, v78
    v_cvt_pk_bf16_f32 v89, v89, v89
    v_lshlrev_b32 v89, 16, v89
    v_mul_f32 v90, v89, v88
    v_fma_f32 v91, -v90, v86, v89
    v_fma_f32 v138, v91, v88, v90
    v_cvt_pk_bf16_f32 v138, v138, v138
    v_lshlrev_b32 v138, 16, v138
    v_sub_f32 v89, v58, v78
    v_cvt_pk_bf16_f32 v89, v89, v89
    v_lshlrev_b32 v89, 16, v89
    v_mul_f32 v90, v89, v88
    v_fma_f32 v91, -v90, v86, v89
    v_fma_f32 v146, v91, v88, v90
    v_cvt_pk_bf16_f32 v146, v146, v146
    v_lshlrev_b32 v146, 16, v146
    v_mul_f32 v87, 0x3b000000, v87
    v_cvt_pk_bf16_f32 v87, v87, v87
    v_lshlrev_b32 v87, 16, v87
    v_add_f32 v87, 0x3727c5ac, v87
    v_cvt_pk_bf16_f32 v87, v87, v87
    v_lshlrev_b32 v87, 16, v87
    v_sqrt_f32 v87, v87
    s_nop 0
    v_cvt_pk_bf16_f32 v87, v87, v87
    v_lshlrev_b32 v87, 16, v87
    v_cvt_pk_bf16_f32 v79, v79, v79
    v_lshlrev_b32 v79, 16, v79
    v_rcp_f32 v88, v87
    s_nop 0
    v_sub_f32 v89, v51, v79
    v_cvt_pk_bf16_f32 v89, v89, v89
    v_lshlrev_b32 v89, 16, v89
    v_mul_f32 v90, v89, v88
    v_fma_f32 v91, -v90, v87, v89
    v_fma_f32 v139, v91, v88, v90
    v_cvt_pk_bf16_f32 v139, v139, v139
    v_lshlrev_b32 v139, 16, v139
    v_sub_f32 v89, v59, v79
    v_cvt_pk_bf16_f32 v89, v89, v89
    v_lshlrev_b32 v89, 16, v89
    v_mul_f32 v90, v89, v88
    v_fma_f32 v91, -v90, v87, v89
    v_fma_f32 v147, v91, v88, v90
    v_cvt_pk_bf16_f32 v147, v147, v147
    v_lshlrev_b32 v147, 16, v147
    v_lshlrev_b32 v41, 16, v40
    v_and_b32 v42, 0xffff0000, v40
    v_lshlrev_b32 v92, 16, v24
    v_lshlrev_b32 v93, 16, v32
    v_mul_f32 v92, v92, v41
    v_cvt_pk_bf16_f32 v92, v92, v92
    v_lshlrev_b32 v92, 16, v92
    v_add_f32 v93, v93, v92
    v_cvt_pk_bf16_f32 v93, v93, v93
    v_lshlrev_b32 v93, 16, v93
    v_mul_f32 v93, v93, v132
    v_cvt_pk_bf16_f32 v93, v93, v93
    v_lshlrev_b32 v93, 16, v93
    v_add_f32 v44, v44, v93
    v_cvt_pk_bf16_f32 v44, v44, v44
    v_lshlrev_b32 v44, 16, v44
    v_lshlrev_b32 v92, 16, v28
    v_lshlrev_b32 v93, 16, v36
    v_mul_f32 v92, v92, v42
    v_cvt_pk_bf16_f32 v92, v92, v92
    v_lshlrev_b32 v92, 16, v92
    v_add_f32 v93, v93, v92
    v_cvt_pk_bf16_f32 v93, v93, v93
    v_lshlrev_b32 v93, 16, v93
    v_mul_f32 v93, v93, v140
    v_cvt_pk_bf16_f32 v93, v93, v93
    v_lshlrev_b32 v93, 16, v93
    v_add_f32 v52, v52, v93
    v_cvt_pk_bf16_f32 v52, v52, v52
    v_lshlrev_b32 v52, 16, v52
    v_and_b32 v92, 0xffff0000, v24
    v_and_b32 v93, 0xffff0000, v32
    v_mul_f32 v92, v92, v41
    v_cvt_pk_bf16_f32 v92, v92, v92
    v_lshlrev_b32 v92, 16, v92
    v_add_f32 v93, v93, v92
    v_cvt_pk_bf16_f32 v93, v93, v93
    v_lshlrev_b32 v93, 16, v93
    v_mul_f32 v93, v93, v133
    v_cvt_pk_bf16_f32 v93, v93, v93
    v_lshlrev_b32 v93, 16, v93
    v_add_f32 v45, v45, v93
    v_cvt_pk_bf16_f32 v45, v45, v45
    v_lshlrev_b32 v45, 16, v45
    v_and_b32 v92, 0xffff0000, v28
    v_and_b32 v93, 0xffff0000, v36
    v_mul_f32 v92, v92, v42
    v_cvt_pk_bf16_f32 v92, v92, v92
    v_lshlrev_b32 v92, 16, v92
    v_add_f32 v93, v93, v92
    v_cvt_pk_bf16_f32 v93, v93, v93
    v_lshlrev_b32 v93, 16, v93
    v_mul_f32 v93, v93, v141
    v_cvt_pk_bf16_f32 v93, v93, v93
    v_lshlrev_b32 v93, 16, v93
    v_add_f32 v53, v53, v93
    v_cvt_pk_bf16_f32 v53, v53, v53
    v_lshlrev_b32 v53, 16, v53
    v_lshlrev_b32 v92, 16, v25
    v_lshlrev_b32 v93, 16, v33
    v_mul_f32 v92, v92, v41
    v_cvt_pk_bf16_f32 v92, v92, v92
    v_lshlrev_b32 v92, 16, v92
    v_add_f32 v93, v93, v92
    v_cvt_pk_bf16_f32 v93, v93, v93
    v_lshlrev_b32 v93, 16, v93
    v_mul_f32 v93, v93, v134
    v_cvt_pk_bf16_f32 v93, v93, v93
    v_lshlrev_b32 v93, 16, v93
    v_add_f32 v46, v46, v93
    v_cvt_pk_bf16_f32 v46, v46, v46
    v_lshlrev_b32 v46, 16, v46
    v_lshlrev_b32 v92, 16, v29
    v_lshlrev_b32 v93, 16, v37
    v_mul_f32 v92, v92, v42
    v_cvt_pk_bf16_f32 v92, v92, v92
    v_lshlrev_b32 v92, 16, v92
    v_add_f32 v93, v93, v92
    v_cvt_pk_bf16_f32 v93, v93, v93
    v_lshlrev_b32 v93, 16, v93
    v_mul_f32 v93, v93, v142
    v_cvt_pk_bf16_f32 v93, v93, v93
    v_lshlrev_b32 v93, 16, v93
    v_add_f32 v54, v54, v93
    v_cvt_pk_bf16_f32 v54, v54, v54
    v_lshlrev_b32 v54, 16, v54
    v_and_b32 v92, 0xffff0000, v25
    v_and_b32 v93, 0xffff0000, v33
    v_mul_f32 v92, v92, v41
    v_cvt_pk_bf16_f32 v92, v92, v92
    v_lshlrev_b32 v92, 16, v92
    v_add_f32 v93, v93, v92
    v_cvt_pk_bf16_f32 v93, v93, v93
    v_lshlrev_b32 v93, 16, v93
    v_mul_f32 v93, v93, v135
    v_cvt_pk_bf16_f32 v93, v93, v93
    v_lshlrev_b32 v93, 16, v93
    v_add_f32 v47, v47, v93
    v_cvt_pk_bf16_f32 v47, v47, v47
    v_lshlrev_b32 v47, 16, v47
    v_and_b32 v92, 0xffff0000, v29
    v_and_b32 v93, 0xffff0000, v37
    v_mul_f32 v92, v92, v42
    v_cvt_pk_bf16_f32 v92, v92, v92
    v_lshlrev_b32 v92, 16, v92
    v_add_f32 v93, v93, v92
    v_cvt_pk_bf16_f32 v93, v93, v93
    v_lshlrev_b32 v93, 16, v93
    v_mul_f32 v93, v93, v143
    v_cvt_pk_bf16_f32 v93, v93, v93
    v_lshlrev_b32 v93, 16, v93
    v_add_f32 v55, v55, v93
    v_cvt_pk_bf16_f32 v55, v55, v55
    v_lshlrev_b32 v55, 16, v55
    v_lshlrev_b32 v92, 16, v26
    v_lshlrev_b32 v93, 16, v34
    v_mul_f32 v92, v92, v41
    v_cvt_pk_bf16_f32 v92, v92, v92
    v_lshlrev_b32 v92, 16, v92
    v_add_f32 v93, v93, v92
    v_cvt_pk_bf16_f32 v93, v93, v93
    v_lshlrev_b32 v93, 16, v93
    v_mul_f32 v93, v93, v136
    v_cvt_pk_bf16_f32 v93, v93, v93
    v_lshlrev_b32 v93, 16, v93
    v_add_f32 v48, v48, v93
    v_cvt_pk_bf16_f32 v48, v48, v48
    v_lshlrev_b32 v48, 16, v48
    v_lshlrev_b32 v92, 16, v30
    v_lshlrev_b32 v93, 16, v38
    v_mul_f32 v92, v92, v42
    v_cvt_pk_bf16_f32 v92, v92, v92
    v_lshlrev_b32 v92, 16, v92
    v_add_f32 v93, v93, v92
    v_cvt_pk_bf16_f32 v93, v93, v93
    v_lshlrev_b32 v93, 16, v93
    v_mul_f32 v93, v93, v144
    v_cvt_pk_bf16_f32 v93, v93, v93
    v_lshlrev_b32 v93, 16, v93
    v_add_f32 v56, v56, v93
    v_cvt_pk_bf16_f32 v56, v56, v56
    v_lshlrev_b32 v56, 16, v56
    v_and_b32 v92, 0xffff0000, v26
    v_and_b32 v93, 0xffff0000, v34
    v_mul_f32 v92, v92, v41
    v_cvt_pk_bf16_f32 v92, v92, v92
    v_lshlrev_b32 v92, 16, v92
    v_add_f32 v93, v93, v92
    v_cvt_pk_bf16_f32 v93, v93, v93
    v_lshlrev_b32 v93, 16, v93
    v_mul_f32 v93, v93, v137
    v_cvt_pk_bf16_f32 v93, v93, v93
    v_lshlrev_b32 v93, 16, v93
    v_add_f32 v49, v49, v93
    v_cvt_pk_bf16_f32 v49, v49, v49
    v_lshlrev_b32 v49, 16, v49
    v_and_b32 v92, 0xffff0000, v30
    v_and_b32 v93, 0xffff0000, v38
    v_mul_f32 v92, v92, v42
    v_cvt_pk_bf16_f32 v92, v92, v92
    v_lshlrev_b32 v92, 16, v92
    v_add_f32 v93, v93, v92
    v_cvt_pk_bf16_f32 v93, v93, v93
    v_lshlrev_b32 v93, 16, v93
    v_mul_f32 v93, v93, v145
    v_cvt_pk_bf16_f32 v93, v93, v93
    v_lshlrev_b32 v93, 16, v93
    v_add_f32 v57, v57, v93
    v_cvt_pk_bf16_f32 v57, v57, v57
    v_lshlrev_b32 v57, 16, v57
    v_lshlrev_b32 v92, 16, v27
    v_lshlrev_b32 v93, 16, v35
    v_mul_f32 v92, v92, v41
    v_cvt_pk_bf16_f32 v92, v92, v92
    v_lshlrev_b32 v92, 16, v92
    v_add_f32 v93, v93, v92
    v_cvt_pk_bf16_f32 v93, v93, v93
    v_lshlrev_b32 v93, 16, v93
    v_mul_f32 v93, v93, v138
    v_cvt_pk_bf16_f32 v93, v93, v93
    v_lshlrev_b32 v93, 16, v93
    v_add_f32 v50, v50, v93
    v_cvt_pk_bf16_f32 v50, v50, v50
    v_lshlrev_b32 v50, 16, v50
    v_lshlrev_b32 v92, 16, v31
    v_lshlrev_b32 v93, 16, v39
    v_mul_f32 v92, v92, v42
    v_cvt_pk_bf16_f32 v92, v92, v92
    v_lshlrev_b32 v92, 16, v92
    v_add_f32 v93, v93, v92
    v_cvt_pk_bf16_f32 v93, v93, v93
    v_lshlrev_b32 v93, 16, v93
    v_mul_f32 v93, v93, v146
    v_cvt_pk_bf16_f32 v93, v93, v93
    v_lshlrev_b32 v93, 16, v93
    v_add_f32 v58, v58, v93
    v_cvt_pk_bf16_f32 v58, v58, v58
    v_lshlrev_b32 v58, 16, v58
    v_and_b32 v92, 0xffff0000, v27
    v_and_b32 v93, 0xffff0000, v35
    v_mul_f32 v92, v92, v41
    v_cvt_pk_bf16_f32 v92, v92, v92
    v_lshlrev_b32 v92, 16, v92
    v_add_f32 v93, v93, v92
    v_cvt_pk_bf16_f32 v93, v93, v93
    v_lshlrev_b32 v93, 16, v93
    v_mul_f32 v93, v93, v139
    v_cvt_pk_bf16_f32 v93, v93, v93
    v_lshlrev_b32 v93, 16, v93
    v_add_f32 v51, v51, v93
    v_cvt_pk_bf16_f32 v51, v51, v51
    v_lshlrev_b32 v51, 16, v51
    v_and_b32 v92, 0xffff0000, v31
    v_and_b32 v93, 0xffff0000, v39
    v_mul_f32 v92, v92, v42
    v_cvt_pk_bf16_f32 v92, v92, v92
    v_lshlrev_b32 v92, 16, v92
    v_add_f32 v93, v93, v92
    v_cvt_pk_bf16_f32 v93, v93, v93
    v_lshlrev_b32 v93, 16, v93
    v_mul_f32 v93, v93, v147
    v_cvt_pk_bf16_f32 v93, v93, v93
    v_lshlrev_b32 v93, 16, v93
    v_add_f32 v59, v59, v93
    v_cvt_pk_bf16_f32 v59, v59, v59
    v_lshlrev_b32 v59, 16, v59
    s_mov_b32 s25, 4194304
    s_mov_b32 s26, 6291456
    v_cvt_pk_bf16_f32 v94, v44, v52
    buffer_store_dword v94, v2, s[20:23], s25 offen offset:0
    v_cvt_pk_bf16_f32 v94, v45, v53
    buffer_store_dword v94, v2, s[20:23], s25 offen offset:1024
    v_cvt_pk_bf16_f32 v94, v46, v54
    buffer_store_dword v94, v2, s[20:23], s25 offen offset:2048
    v_cvt_pk_bf16_f32 v94, v47, v55
    buffer_store_dword v94, v2, s[20:23], s25 offen offset:3072
    v_cvt_pk_bf16_f32 v94, v48, v56
    buffer_store_dword v94, v3, s[20:23], s25 offen offset:0
    v_cvt_pk_bf16_f32 v94, v49, v57
    buffer_store_dword v94, v3, s[20:23], s25 offen offset:1024
    v_cvt_pk_bf16_f32 v94, v50, v58
    buffer_store_dword v94, v3, s[20:23], s25 offen offset:2048
    v_cvt_pk_bf16_f32 v94, v51, v59
    buffer_store_dword v94, v3, s[20:23], s25 offen offset:3072
    v_add_f32 v64, v44, v52
    v_add_f32 v65, v45, v53
    v_add_f32 v66, v46, v54
    v_add_f32 v67, v47, v55
    v_add_f32 v68, v48, v56
    v_add_f32 v69, v49, v57
    v_add_f32 v70, v50, v58
    v_add_f32 v71, v51, v59
    v_add_f32_dpp v64, v64, v64 quad_perm:[1,0,3,2] row_mask:0xf bank_mask:0xf
    v_add_f32_dpp v65, v65, v65 quad_perm:[1,0,3,2] row_mask:0xf bank_mask:0xf
    v_add_f32_dpp v66, v66, v66 quad_perm:[1,0,3,2] row_mask:0xf bank_mask:0xf
    v_add_f32_dpp v67, v67, v67 quad_perm:[1,0,3,2] row_mask:0xf bank_mask:0xf
    v_add_f32_dpp v68, v68, v68 quad_perm:[1,0,3,2] row_mask:0xf bank_mask:0xf
    v_add_f32_dpp v69, v69, v69 quad_perm:[1,0,3,2] row_mask:0xf bank_mask:0xf
    v_add_f32_dpp v70, v70, v70 quad_perm:[1,0,3,2] row_mask:0xf bank_mask:0xf
    v_add_f32_dpp v71, v71, v71 quad_perm:[1,0,3,2] row_mask:0xf bank_mask:0xf
    v_add_f32_dpp v64, v64, v64 quad_perm:[2,3,0,1] row_mask:0xf bank_mask:0xf
    v_add_f32_dpp v65, v65, v65 quad_perm:[2,3,0,1] row_mask:0xf bank_mask:0xf
    v_add_f32_dpp v66, v66, v66 quad_perm:[2,3,0,1] row_mask:0xf bank_mask:0xf
    v_add_f32_dpp v67, v67, v67 quad_perm:[2,3,0,1] row_mask:0xf bank_mask:0xf
    v_add_f32_dpp v68, v68, v68 quad_perm:[2,3,0,1] row_mask:0xf bank_mask:0xf
    v_add_f32_dpp v69, v69, v69 quad_perm:[2,3,0,1] row_mask:0xf bank_mask:0xf
    v_add_f32_dpp v70, v70, v70 quad_perm:[2,3,0,1] row_mask:0xf bank_mask:0xf
    v_add_f32_dpp v71, v71, v71 quad_perm:[2,3,0,1] row_mask:0xf bank_mask:0xf
    v_add_f32_dpp v64, v64, v64 row_half_mirror row_mask:0xf bank_mask:0xf
    v_add_f32_dpp v65, v65, v65 row_half_mirror row_mask:0xf bank_mask:0xf
    v_add_f32_dpp v66, v66, v66 row_half_mirror row_mask:0xf bank_mask:0xf
    v_add_f32_dpp v67, v67, v67 row_half_mirror row_mask:0xf bank_mask:0xf
    v_add_f32_dpp v68, v68, v68 row_half_mirror row_mask:0xf bank_mask:0xf
    v_add_f32_dpp v69, v69, v69 row_half_mirror row_mask:0xf bank_mask:0xf
    v_add_f32_dpp v70, v70, v70 row_half_mirror row_mask:0xf bank_mask:0xf
    v_add_f32_dpp v71, v71, v71 row_half_mirror row_mask:0xf bank_mask:0xf
    v_add_f32_dpp v64, v64, v64 row_mirror row_mask:0xf bank_mask:0xf
    v_add_f32_dpp v65, v65, v65 row_mirror row_mask:0xf bank_mask:0xf
    v_add_f32_dpp v66, v66, v66 row_mirror row_mask:0xf bank_mask:0xf
    v_add_f32_dpp v67, v67, v67 row_mirror row_mask:0xf bank_mask:0xf
    v_add_f32_dpp v68, v68, v68 row_mirror row_mask:0xf bank_mask:0xf
    v_add_f32_dpp v69, v69, v69 row_mirror row_mask:0xf bank_mask:0xf
    v_add_f32_dpp v70, v70, v70 row_mirror row_mask:0xf bank_mask:0xf
    v_add_f32_dpp v71, v71, v71 row_mirror row_mask:0xf bank_mask:0xf
    v_add_f32_dpp v64, v64, v64 row_bcast:15 row_mask:0xa bank_mask:0xf
    v_add_f32_dpp v65, v65, v65 row_bcast:15 row_mask:0xa bank_mask:0xf
    v_add_f32_dpp v66, v66, v66 row_bcast:15 row_mask:0xa bank_mask:0xf
    v_add_f32_dpp v67, v67, v67 row_bcast:15 row_mask:0xa bank_mask:0xf
    v_add_f32_dpp v68, v68, v68 row_bcast:15 row_mask:0xa bank_mask:0xf
    v_add_f32_dpp v69, v69, v69 row_bcast:15 row_mask:0xa bank_mask:0xf
    v_add_f32_dpp v70, v70, v70 row_bcast:15 row_mask:0xa bank_mask:0xf
    v_add_f32_dpp v71, v71, v71 row_bcast:15 row_mask:0xa bank_mask:0xf
    v_add_f32_dpp v64, v64, v64 row_bcast:31 row_mask:0xc bank_mask:0xf
    v_add_f32_dpp v65, v65, v65 row_bcast:31 row_mask:0xc bank_mask:0xf
    v_add_f32_dpp v66, v66, v66 row_bcast:31 row_mask:0xc bank_mask:0xf
    v_add_f32_dpp v67, v67, v67 row_bcast:31 row_mask:0xc bank_mask:0xf
    v_add_f32_dpp v68, v68, v68 row_bcast:31 row_mask:0xc bank_mask:0xf
    v_add_f32_dpp v69, v69, v69 row_bcast:31 row_mask:0xc bank_mask:0xf
    v_add_f32_dpp v70, v70, v70 row_bcast:31 row_mask:0xc bank_mask:0xf
    v_add_f32_dpp v71, v71, v71 row_bcast:31 row_mask:0xc bank_mask:0xf
    s_nop 1
    s_mov_b64 s[40:41], exec
    s_mov_b64 exec, s[42:43]
    ds_write_b128 v8, v[64:67] offset:256
    ds_write_b128 v8, v[68:71] offset:272
    s_mov_b64 exec, s[40:41]
    s_waitcnt lgkmcnt(0)
    s_barrier

    ds_read_b128 v[100:103], v9 offset:256
    ds_read_b128 v[104:107], v9 offset:272
    ds_read_b128 v[108:111], v9 offset:288
    ds_read_b128 v[112:115], v9 offset:304
    ds_read_b128 v[116:119], v9 offset:320
    ds_read_b128 v[120:123], v9 offset:336
    ds_read_b128 v[124:127], v9 offset:352
    ds_read_b128 v[128:131], v9 offset:368
    s_waitcnt lgkmcnt(0)
    v_add_f32 v72, v100, v108
    v_add_f32 v116, v116, v124
    v_add_f32 v73, v101, v109
    v_add_f32 v117, v117, v125
    v_add_f32 v74, v102, v110
    v_add_f32 v118, v118, v126
    v_add_f32 v75, v103, v111
    v_add_f32 v119, v119, v127
    v_add_f32 v76, v104, v112
    v_add_f32 v120, v120, v128
    v_add_f32 v77, v105, v113
    v_add_f32 v121, v121, v129
    v_add_f32 v78, v106, v114
    v_add_f32 v122, v122, v130
    v_add_f32 v79, v107, v115
    v_add_f32 v123, v123, v131
    v_add_f32 v72, v72, v116
    v_add_f32 v73, v73, v117
    v_add_f32 v74, v74, v118
    v_add_f32 v75, v75, v119
    v_add_f32 v76, v76, v120
    v_add_f32 v77, v77, v121
    v_add_f32 v78, v78, v122
    v_add_f32 v79, v79, v123
    v_mul_f32 v72, 0x3b000000, v72
    v_mul_f32 v73, 0x3b000000, v73
    v_mul_f32 v74, 0x3b000000, v74
    v_mul_f32 v75, 0x3b000000, v75
    v_mul_f32 v76, 0x3b000000, v76
    v_mul_f32 v77, 0x3b000000, v77
    v_mul_f32 v78, 0x3b000000, v78
    v_mul_f32 v79, 0x3b000000, v79
    v_sub_f32 v80, v44, v72
    v_sub_f32 v81, v52, v72
    v_mul_f32 v80, v80, v80
    v_fma_f32 v64, v81, v81, v80
    v_sub_f32 v80, v45, v73
    v_sub_f32 v81, v53, v73
    v_mul_f32 v80, v80, v80
    v_fma_f32 v65, v81, v81, v80
    v_sub_f32 v80, v46, v74
    v_sub_f32 v81, v54, v74
    v_mul_f32 v80, v80, v80
    v_fma_f32 v66, v81, v81, v80
    v_sub_f32 v80, v47, v75
    v_sub_f32 v81, v55, v75
    v_mul_f32 v80, v80, v80
    v_fma_f32 v67, v81, v81, v80
    v_sub_f32 v80, v48, v76
    v_sub_f32 v81, v56, v76
    v_mul_f32 v80, v80, v80
    v_fma_f32 v68, v81, v81, v80
    v_sub_f32 v80, v49, v77
    v_sub_f32 v81, v57, v77
    v_mul_f32 v80, v80, v80
    v_fma_f32 v69, v81, v81, v80
    v_sub_f32 v80, v50, v78
    v_sub_f32 v81, v58, v78
    v_mul_f32 v80, v80, v80
    v_fma_f32 v70, v81, v81, v80
    v_sub_f32 v80, v51, v79
    v_sub_f32 v81, v59, v79
    v_mul_f32 v80, v80, v80
    v_fma_f32 v71, v81, v81, v80
    v_add_f32_dpp v64, v64, v64 quad_perm:[1,0,3,2] row_mask:0xf bank_mask:0xf
    v_add_f32_dpp v65, v65, v65 quad_perm:[1,0,3,2] row_mask:0xf bank_mask:0xf
    v_add_f32_dpp v66, v66, v66 quad_perm:[1,0,3,2] row_mask:0xf bank_mask:0xf
    v_add_f32_dpp v67, v67, v67 quad_perm:[1,0,3,2] row_mask:0xf bank_mask:0xf
    v_add_f32_dpp v68, v68, v68 quad_perm:[1,0,3,2] row_mask:0xf bank_mask:0xf
    v_add_f32_dpp v69, v69, v69 quad_perm:[1,0,3,2] row_mask:0xf bank_mask:0xf
    v_add_f32_dpp v70, v70, v70 quad_perm:[1,0,3,2] row_mask:0xf bank_mask:0xf
    v_add_f32_dpp v71, v71, v71 quad_perm:[1,0,3,2] row_mask:0xf bank_mask:0xf
    v_add_f32_dpp v64, v64, v64 quad_perm:[2,3,0,1] row_mask:0xf bank_mask:0xf
    v_add_f32_dpp v65, v65, v65 quad_perm:[2,3,0,1] row_mask:0xf bank_mask:0xf
    v_add_f32_dpp v66, v66, v66 quad_perm:[2,3,0,1] row_mask:0xf bank_mask:0xf
    v_add_f32_dpp v67, v67, v67 quad_perm:[2,3,0,1] row_mask:0xf bank_mask:0xf
    v_add_f32_dpp v68, v68, v68 quad_perm:[2,3,0,1] row_mask:0xf bank_mask:0xf
    v_add_f32_dpp v69, v69, v69 quad_perm:[2,3,0,1] row_mask:0xf bank_mask:0xf
    v_add_f32_dpp v70, v70, v70 quad_perm:[2,3,0,1] row_mask:0xf bank_mask:0xf
    v_add_f32_dpp v71, v71, v71 quad_perm:[2,3,0,1] row_mask:0xf bank_mask:0xf
    v_add_f32_dpp v64, v64, v64 row_half_mirror row_mask:0xf bank_mask:0xf
    v_add_f32_dpp v65, v65, v65 row_half_mirror row_mask:0xf bank_mask:0xf
    v_add_f32_dpp v66, v66, v66 row_half_mirror row_mask:0xf bank_mask:0xf
    v_add_f32_dpp v67, v67, v67 row_half_mirror row_mask:0xf bank_mask:0xf
    v_add_f32_dpp v68, v68, v68 row_half_mirror row_mask:0xf bank_mask:0xf
    v_add_f32_dpp v69, v69, v69 row_half_mirror row_mask:0xf bank_mask:0xf
    v_add_f32_dpp v70, v70, v70 row_half_mirror row_mask:0xf bank_mask:0xf
    v_add_f32_dpp v71, v71, v71 row_half_mirror row_mask:0xf bank_mask:0xf
    v_add_f32_dpp v64, v64, v64 row_mirror row_mask:0xf bank_mask:0xf
    v_add_f32_dpp v65, v65, v65 row_mirror row_mask:0xf bank_mask:0xf
    v_add_f32_dpp v66, v66, v66 row_mirror row_mask:0xf bank_mask:0xf
    v_add_f32_dpp v67, v67, v67 row_mirror row_mask:0xf bank_mask:0xf
    v_add_f32_dpp v68, v68, v68 row_mirror row_mask:0xf bank_mask:0xf
    v_add_f32_dpp v69, v69, v69 row_mirror row_mask:0xf bank_mask:0xf
    v_add_f32_dpp v70, v70, v70 row_mirror row_mask:0xf bank_mask:0xf
    v_add_f32_dpp v71, v71, v71 row_mirror row_mask:0xf bank_mask:0xf
    v_add_f32_dpp v64, v64, v64 row_bcast:15 row_mask:0xa bank_mask:0xf
    v_add_f32_dpp v65, v65, v65 row_bcast:15 row_mask:0xa bank_mask:0xf
    v_add_f32_dpp v66, v66, v66 row_bcast:15 row_mask:0xa bank_mask:0xf
    v_add_f32_dpp v67, v67, v67 row_bcast:15 row_mask:0xa bank_mask:0xf
    v_add_f32_dpp v68, v68, v68 row_bcast:15 row_mask:0xa bank_mask:0xf
    v_add_f32_dpp v69, v69, v69 row_bcast:15 row_mask:0xa bank_mask:0xf
    v_add_f32_dpp v70, v70, v70 row_bcast:15 row_mask:0xa bank_mask:0xf
    v_add_f32_dpp v71, v71, v71 row_bcast:15 row_mask:0xa bank_mask:0xf
    v_add_f32_dpp v64, v64, v64 row_bcast:31 row_mask:0xc bank_mask:0xf
    v_add_f32_dpp v65, v65, v65 row_bcast:31 row_mask:0xc bank_mask:0xf
    v_add_f32_dpp v66, v66, v66 row_bcast:31 row_mask:0xc bank_mask:0xf
    v_add_f32_dpp v67, v67, v67 row_bcast:31 row_mask:0xc bank_mask:0xf
    v_add_f32_dpp v68, v68, v68 row_bcast:31 row_mask:0xc bank_mask:0xf
    v_add_f32_dpp v69, v69, v69 row_bcast:31 row_mask:0xc bank_mask:0xf
    v_add_f32_dpp v70, v70, v70 row_bcast:31 row_mask:0xc bank_mask:0xf
    v_add_f32_dpp v71, v71, v71 row_bcast:31 row_mask:0xc bank_mask:0xf
    s_nop 1
    s_mov_b64 s[40:41], exec
    s_mov_b64 exec, s[42:43]
    ds_write_b128 v8, v[64:67] offset:384
    ds_write_b128 v8, v[68:71] offset:400
    s_mov_b64 exec, s[40:41]
    s_waitcnt lgkmcnt(0)
    s_barrier

    ds_read_b128 v[100:103], v9 offset:384
    ds_read_b128 v[104:107], v9 offset:400
    ds_read_b128 v[108:111], v9 offset:416
    ds_read_b128 v[112:115], v9 offset:432
    ds_read_b128 v[116:119], v9 offset:448
    ds_read_b128 v[120:123], v9 offset:464
    ds_read_b128 v[124:127], v9 offset:480
    ds_read_b128 v[128:131], v9 offset:496
    s_waitcnt lgkmcnt(0)
    v_add_f32 v80, v100, v108
    v_add_f32 v116, v116, v124
    v_add_f32 v81, v101, v109
    v_add_f32 v117, v117, v125
    v_add_f32 v82, v102, v110
    v_add_f32 v118, v118, v126
    v_add_f32 v83, v103, v111
    v_add_f32 v119, v119, v127
    v_add_f32 v84, v104, v112
    v_add_f32 v120, v120, v128
    v_add_f32 v85, v105, v113
    v_add_f32 v121, v121, v129
    v_add_f32 v86, v106, v114
    v_add_f32 v122, v122, v130
    v_add_f32 v87, v107, v115
    v_add_f32 v123, v123, v131
    v_add_f32 v80, v80, v116
    v_add_f32 v81, v81, v117
    v_add_f32 v82, v82, v118
    v_add_f32 v83, v83, v119
    v_add_f32 v84, v84, v120
    v_add_f32 v85, v85, v121
    v_add_f32 v86, v86, v122
    v_add_f32 v87, v87, v123
    v_mul_f32 v80, 0x3b000000, v80
    v_cvt_pk_bf16_f32 v80, v80, v80
    v_lshlrev_b32 v80, 16, v80
    v_add_f32 v80, 0x3727c5ac, v80
    v_cvt_pk_bf16_f32 v80, v80, v80
    v_lshlrev_b32 v80, 16, v80
    v_sqrt_f32 v80, v80
    s_nop 0
    v_cvt_pk_bf16_f32 v80, v80, v80
    v_lshlrev_b32 v80, 16, v80
    v_cvt_pk_bf16_f32 v72, v72, v72
    v_lshlrev_b32 v72, 16, v72
    v_rcp_f32 v88, v80
    s_nop 0
    v_sub_f32 v89, v44, v72
    v_cvt_pk_bf16_f32 v89, v89, v89
    v_lshlrev_b32 v89, 16, v89
    v_mul_f32 v90, v89, v88
    v_fma_f32 v91, -v90, v80, v89
    v_fma_f32 v132, v91, v88, v90
    v_cvt_pk_bf16_f32 v132, v132, v132
    v_lshlrev_b32 v132, 16, v132
    v_sub_f32 v89, v52, v72
    v_cvt_pk_bf16_f32 v89, v89, v89
    v_lshlrev_b32 v89, 16, v89
    v_mul_f32 v90, v89, v88
    v_fma_f32 v91, -v90, v80, v89
    v_fma_f32 v140, v91, v88, v90
    v_cvt_pk_bf16_f32 v140, v140, v140
    v_lshlrev_b32 v140, 16, v140
    v_mul_f32 v81, 0x3b000000, v81
    v_cvt_pk_bf16_f32 v81, v81, v81
    v_lshlrev_b32 v81, 16, v81
    v_add_f32 v81, 0x3727c5ac, v81
    v_cvt_pk_bf16_f32 v81, v81, v81
    v_lshlrev_b32 v81, 16, v81
    v_sqrt_f32 v81, v81
    s_nop 0
    v_cvt_pk_bf16_f32 v81, v81, v81
    v_lshlrev_b32 v81, 16, v81
    v_cvt_pk_bf16_f32 v73, v73, v73
    v_lshlrev_b32 v73, 16, v73
    v_rcp_f32 v88, v81
    s_nop 0
    v_sub_f32 v89, v45, v73
    v_cvt_pk_bf16_f32 v89, v89, v89
    v_lshlrev_b32 v89, 16, v89
    v_mul_f32 v90, v89, v88
    v_fma_f32 v91, -v90, v81, v89
    v_fma_f32 v133, v91, v88, v90
    v_cvt_pk_bf16_f32 v133, v133, v133
    v_lshlrev_b32 v133, 16, v133
    v_sub_f32 v89, v53, v73
    v_cvt_pk_bf16_f32 v89, v89, v89
    v_lshlrev_b32 v89, 16, v89
    v_mul_f32 v90, v89, v88
    v_fma_f32 v91, -v90, v81, v89
    v_fma_f32 v141, v91, v88, v90
    v_cvt_pk_bf16_f32 v141, v141, v141
    v_lshlrev_b32 v141, 16, v141
    v_mul_f32 v82, 0x3b000000, v82
    v_cvt_pk_bf16_f32 v82, v82, v82
    v_lshlrev_b32 v82, 16, v82
    v_add_f32 v82, 0x3727c5ac, v82
    v_cvt_pk_bf16_f32 v82, v82, v82
    v_lshlrev_b32 v82, 16, v82
    v_sqrt_f32 v82, v82
    s_nop 0
    v_cvt_pk_bf16_f32 v82, v82, v82
    v_lshlrev_b32 v82, 16, v82
    v_cvt_pk_bf16_f32 v74, v74, v74
    v_lshlrev_b32 v74, 16, v74
    v_rcp_f32 v88, v82
    s_nop 0
    v_sub_f32 v89, v46, v74
    v_cvt_pk_bf16_f32 v89, v89, v89
    v_lshlrev_b32 v89, 16, v89
    v_mul_f32 v90, v89, v88
    v_fma_f32 v91, -v90, v82, v89
    v_fma_f32 v134, v91, v88, v90
    v_cvt_pk_bf16_f32 v134, v134, v134
    v_lshlrev_b32 v134, 16, v134
    v_sub_f32 v89, v54, v74
    v_cvt_pk_bf16_f32 v89, v89, v89
    v_lshlrev_b32 v89, 16, v89
    v_mul_f32 v90, v89, v88
    v_fma_f32 v91, -v90, v82, v89
    v_fma_f32 v142, v91, v88, v90
    v_cvt_pk_bf16_f32 v142, v142, v142
    v_lshlrev_b32 v142, 16, v142
    v_mul_f32 v83, 0x3b000000, v83
    v_cvt_pk_bf16_f32 v83, v83, v83
    v_lshlrev_b32 v83, 16, v83
    v_add_f32 v83, 0x3727c5ac, v83
    v_cvt_pk_bf16_f32 v83, v83, v83
    v_lshlrev_b32 v83, 16, v83
    v_sqrt_f32 v83, v83
    s_nop 0
    v_cvt_pk_bf16_f32 v83, v83, v83
    v_lshlrev_b32 v83, 16, v83
    v_cvt_pk_bf16_f32 v75, v75, v75
    v_lshlrev_b32 v75, 16, v75
    v_rcp_f32 v88, v83
    s_nop 0
    v_sub_f32 v89, v47, v75
    v_cvt_pk_bf16_f32 v89, v89, v89
    v_lshlrev_b32 v89, 16, v89
    v_mul_f32 v90, v89, v88
    v_fma_f32 v91, -v90, v83, v89
    v_fma_f32 v135, v91, v88, v90
    v_cvt_pk_bf16_f32 v135, v135, v135
    v_lshlrev_b32 v135, 16, v135
    v_sub_f32 v89, v55, v75
    v_cvt_pk_bf16_f32 v89, v89, v89
    v_lshlrev_b32 v89, 16, v89
    v_mul_f32 v90, v89, v88
    v_fma_f32 v91, -v90, v83, v89
    v_fma_f32 v143, v91, v88, v90
    v_cvt_pk_bf16_f32 v143, v143, v143
    v_lshlrev_b32 v143, 16, v143
    v_mul_f32 v84, 0x3b000000, v84
    v_cvt_pk_bf16_f32 v84, v84, v84
    v_lshlrev_b32 v84, 16, v84
    v_add_f32 v84, 0x3727c5ac, v84
    v_cvt_pk_bf16_f32 v84, v84, v84
    v_lshlrev_b32 v84, 16, v84
    v_sqrt_f32 v84, v84
    s_nop 0
    v_cvt_pk_bf16_f32 v84, v84, v84
    v_lshlrev_b32 v84, 16, v84
    v_cvt_pk_bf16_f32 v76, v76, v76
    v_lshlrev_b32 v76, 16, v76
    v_rcp_f32 v88, v84
    s_nop 0
    v_sub_f32 v89, v48, v76
    v_cvt_pk_bf16_f32 v89, v89, v89
    v_lshlrev_b32 v89, 16, v89
    v_mul_f32 v90, v89, v88
    v_fma_f32 v91, -v90, v84, v89
    v_fma_f32 v136, v91, v88, v90
    v_cvt_pk_bf16_f32 v136, v136, v136
    v_lshlrev_b32 v136, 16, v136
    v_sub_f32 v89, v56, v76
    v_cvt_pk_bf16_f32 v89, v89, v89
    v_lshlrev_b32 v89, 16, v89
    v_mul_f32 v90, v89, v88
    v_fma_f32 v91, -v90, v84, v89
    v_fma_f32 v144, v91, v88, v90
    v_cvt_pk_bf16_f32 v144, v144, v144
    v_lshlrev_b32 v144, 16, v144
    v_mul_f32 v85, 0x3b000000, v85
    v_cvt_pk_bf16_f32 v85, v85, v85
    v_lshlrev_b32 v85, 16, v85
    v_add_f32 v85, 0x3727c5ac, v85
    v_cvt_pk_bf16_f32 v85, v85, v85
    v_lshlrev_b32 v85, 16, v85
    v_sqrt_f32 v85, v85
    s_nop 0
    v_cvt_pk_bf16_f32 v85, v85, v85
    v_lshlrev_b32 v85, 16, v85
    v_cvt_pk_bf16_f32 v77, v77, v77
    v_lshlrev_b32 v77, 16, v77
    v_rcp_f32 v88, v85
    s_nop 0
    v_sub_f32 v89, v49, v77
    v_cvt_pk_bf16_f32 v89, v89, v89
    v_lshlrev_b32 v89, 16, v89
    v_mul_f32 v90, v89, v88
    v_fma_f32 v91, -v90, v85, v89
    v_fma_f32 v137, v91, v88, v90
    v_cvt_pk_bf16_f32 v137, v137, v137
    v_lshlrev_b32 v137, 16, v137
    v_sub_f32 v89, v57, v77
    v_cvt_pk_bf16_f32 v89, v89, v89
    v_lshlrev_b32 v89, 16, v89
    v_mul_f32 v90, v89, v88
    v_fma_f32 v91, -v90, v85, v89
    v_fma_f32 v145, v91, v88, v90
    v_cvt_pk_bf16_f32 v145, v145, v145
    v_lshlrev_b32 v145, 16, v145
    v_mul_f32 v86, 0x3b000000, v86
    v_cvt_pk_bf16_f32 v86, v86, v86
    v_lshlrev_b32 v86, 16, v86
    v_add_f32 v86, 0x3727c5ac, v86
    v_cvt_pk_bf16_f32 v86, v86, v86
    v_lshlrev_b32 v86, 16, v86
    v_sqrt_f32 v86, v86
    s_nop 0
    v_cvt_pk_bf16_f32 v86, v86, v86
    v_lshlrev_b32 v86, 16, v86
    v_cvt_pk_bf16_f32 v78, v78, v78
    v_lshlrev_b32 v78, 16, v78
    v_rcp_f32 v88, v86
    s_nop 0
    v_sub_f32 v89, v50, v78
    v_cvt_pk_bf16_f32 v89, v89, v89
    v_lshlrev_b32 v89, 16, v89
    v_mul_f32 v90, v89, v88
    v_fma_f32 v91, -v90, v86, v89
    v_fma_f32 v138, v91, v88, v90
    v_cvt_pk_bf16_f32 v138, v138, v138
    v_lshlrev_b32 v138, 16, v138
    v_sub_f32 v89, v58, v78
    v_cvt_pk_bf16_f32 v89, v89, v89
    v_lshlrev_b32 v89, 16, v89
    v_mul_f32 v90, v89, v88
    v_fma_f32 v91, -v90, v86, v89
    v_fma_f32 v146, v91, v88, v90
    v_cvt_pk_bf16_f32 v146, v146, v146
    v_lshlrev_b32 v146, 16, v146
    v_mul_f32 v87, 0x3b000000, v87
    v_cvt_pk_bf16_f32 v87, v87, v87
    v_lshlrev_b32 v87, 16, v87
    v_add_f32 v87, 0x3727c5ac, v87
    v_cvt_pk_bf16_f32 v87, v87, v87
    v_lshlrev_b32 v87, 16, v87
    v_sqrt_f32 v87, v87
    s_nop 0
    v_cvt_pk_bf16_f32 v87, v87, v87
    v_lshlrev_b32 v87, 16, v87
    v_cvt_pk_bf16_f32 v79, v79, v79
    v_lshlrev_b32 v79, 16, v79
    v_rcp_f32 v88, v87
    s_nop 0
    v_sub_f32 v89, v51, v79
    v_cvt_pk_bf16_f32 v89, v89, v89
    v_lshlrev_b32 v89, 16, v89
    v_mul_f32 v90, v89, v88
    v_fma_f32 v91, -v90, v87, v89
    v_fma_f32 v139, v91, v88, v90
    v_cvt_pk_bf16_f32 v139, v139, v139
    v_lshlrev_b32 v139, 16, v139
    v_sub_f32 v89, v59, v79
    v_cvt_pk_bf16_f32 v89, v89, v89
    v_lshlrev_b32 v89, 16, v89
    v_mul_f32 v90, v89, v88
    v_fma_f32 v91, -v90, v87, v89
    v_fma_f32 v147, v91, v88, v90
    v_cvt_pk_bf16_f32 v147, v147, v147
    v_lshlrev_b32 v147, 16, v147
    v_cvt_pk_bf16_f32 v94, v132, v140
    buffer_store_dword v94, v2, s[20:23], s26 offen offset:0
    v_cvt_pk_bf16_f32 v94, v133, v141
    buffer_store_dword v94, v2, s[20:23], s26 offen offset:1024
    v_cvt_pk_bf16_f32 v94, v134, v142
    buffer_store_dword v94, v2, s[20:23], s26 offen offset:2048
    v_cvt_pk_bf16_f32 v94, v135, v143
    buffer_store_dword v94, v2, s[20:23], s26 offen offset:3072
    v_cvt_pk_bf16_f32 v94, v136, v144
    buffer_store_dword v94, v3, s[20:23], s26 offen offset:0
    v_cvt_pk_bf16_f32 v94, v137, v145
    buffer_store_dword v94, v3, s[20:23], s26 offen offset:1024
    v_cvt_pk_bf16_f32 v94, v138, v146
    buffer_store_dword v94, v3, s[20:23], s26 offen offset:2048
    v_cvt_pk_bf16_f32 v94, v139, v147
    buffer_store_dword v94, v3, s[20:23], s26 offen offset:3072
K3_END:
    s_endpgm
.globl k4_kernel
.p2align 8
.type k4_kernel,@function
k4_kernel:
    s_cmp_ge_u32 s2, 448
    s_cbranch_scc1 K4_END
    s_load_dwordx4 s[4:7], s[0:1], 56
    s_load_dwordx4 s[8:11], s[0:1], 72
    s_load_dwordx2 s[12:13], s[0:1], 96
    v_and_b32 v1, 63, v0
    v_lshrrev_b32 v2, 6, v0
    s_nop 0
    v_readfirstlane_b32 s14, v2
    s_and_b32 s15, s2, 15
    s_lshr_b32 s16, s2, 4
    s_waitcnt lgkmcnt(0)
    s_add_u32 s18, s12, 6291456
    s_addc_u32 s19, s13, 0

    s_mov_b32 s20, s18
    s_and_b32 s21, s19, 0xffff
    s_mov_b32 s22, 2097152
    s_mov_b32 s23, 0x00020000

    s_mov_b32 s24, s4
    s_and_b32 s25, s5, 0xffff
    s_mov_b32 s26, 1835008
    s_mov_b32 s27, 0x00020000

    s_mov_b32 s28, s6
    s_and_b32 s29, s7, 0xffff
    s_mov_b32 s30, 1835008
    s_mov_b32 s31, 0x00020000

    v_lshrrev_b32 v3, 3, v1
    v_and_b32 v4, 7, v1
    v_xor_b32 v5, v4, v3
    v_lshlrev_b32 v5, 4, v5
    s_lshl_b32 s17, s15, 7
    s_lshl_b32 s32, s14, 5
    s_add_u32 s17, s17, s32
    v_add_u32 v6, s17, v3
    v_mul_u32_u24 v6, 1024, v6
    v_add_u32 v6, v6, v5
    v_lshrrev_b32 v7, 4, v1
    v_and_b32 v7, 1, v7
    v_lshlrev_b32 v7, 2, v7
    v_xor_b32 v7, v7, v4
    v_lshlrev_b32 v7, 4, v7
    s_lshl_b32 s33, s14, 4
    v_add_u32 v8, s33, v3
    v_mul_u32_u24 v8, 3584, v8
    s_lshl_b32 s34, s16, 7
    v_add3_u32 v7, v7, v8, s34
    v_add_u32 v9, 8192, v6
    v_add_u32 v10, 28672, v7

    v_add_u32 v11, 16384, v6
    v_add_u32 v12, 24576, v6
    v_and_b32 v13, 31, v1
    v_lshrrev_b32 v14, 5, v1
    s_lshr_b32 s35, s14, 1
    s_and_b32 s36, s14, 1
    s_lshl_b32 s37, s35, 13
    v_lshlrev_b32 v15, 7, v13
    v_add_u32 v15, s37, v15
    v_and_b32 v16, 7, v13

    v_xor_b32 v17, 0, v14
    v_xor_b32 v17, v17, v16
    v_lshl_add_u32 v20, v17, 4, v15
    v_xor_b32 v17, 2, v14
    v_xor_b32 v17, v17, v16
    v_lshl_add_u32 v21, v17, 4, v15
    v_xor_b32 v17, 4, v14
    v_xor_b32 v17, v17, v16
    v_lshl_add_u32 v22, v17, 4, v15
    v_xor_b32 v17, 6, v14
    v_xor_b32 v17, v17, v16
    v_lshl_add_u32 v23, v17, 4, v15
    v_and_b32 v17, 15, v1
    v_lshrrev_b32 v18, 2, v17
    v_and_b32 v17, 3, v17
    v_lshrrev_b32 v19, 4, v1
    v_lshrrev_b32 v24, 1, v19
    v_and_b32 v19, 1, v19
    v_lshl_add_u32 v24, v24, 3, v18
    v_lshlrev_b32 v25, 1, v19
    v_lshrrev_b32 v26, 1, v17
    v_add_u32 v25, v25, v26
    s_lshl_b32 s38, s36, 2
    v_add_u32 v25, s38, v25
    v_lshrrev_b32 v26, 1, v18
    v_lshlrev_b32 v26, 2, v26
    v_xor_b32 v25, v25, v26
    v_lshlrev_b32 v25, 4, v25
    v_and_b32 v26, 1, v17
    v_lshl_add_u32 v25, v26, 3, v25
    v_lshl_add_u32 v24, v24, 7, v25

    v_accvgpr_write_b32 a0, 0
    v_accvgpr_write_b32 a1, 0
    v_accvgpr_write_b32 a2, 0
    v_accvgpr_write_b32 a3, 0
    v_accvgpr_write_b32 a4, 0
    v_accvgpr_write_b32 a5, 0
    v_accvgpr_write_b32 a6, 0
    v_accvgpr_write_b32 a7, 0
    v_accvgpr_write_b32 a8, 0
    v_accvgpr_write_b32 a9, 0
    v_accvgpr_write_b32 a10, 0
    v_accvgpr_write_b32 a11, 0
    v_accvgpr_write_b32 a12, 0
    v_accvgpr_write_b32 a13, 0
    v_accvgpr_write_b32 a14, 0
    v_accvgpr_write_b32 a15, 0
    v_accvgpr_write_b32 a16, 0
    v_accvgpr_write_b32 a17, 0
    v_accvgpr_write_b32 a18, 0
    v_accvgpr_write_b32 a19, 0
    v_accvgpr_write_b32 a20, 0
    v_accvgpr_write_b32 a21, 0
    v_accvgpr_write_b32 a22, 0
    v_accvgpr_write_b32 a23, 0
    v_accvgpr_write_b32 a24, 0
    v_accvgpr_write_b32 a25, 0
    v_accvgpr_write_b32 a26, 0
    v_accvgpr_write_b32 a27, 0
    v_accvgpr_write_b32 a28, 0
    v_accvgpr_write_b32 a29, 0
    v_accvgpr_write_b32 a30, 0
    v_accvgpr_write_b32 a31, 0
    v_accvgpr_write_b32 a32, 0
    v_accvgpr_write_b32 a33, 0
    v_accvgpr_write_b32 a34, 0
    v_accvgpr_write_b32 a35, 0
    v_accvgpr_write_b32 a36, 0
    v_accvgpr_write_b32 a37, 0
    v_accvgpr_write_b32 a38, 0
    v_accvgpr_write_b32 a39, 0
    v_accvgpr_write_b32 a40, 0
    v_accvgpr_write_b32 a41, 0
    v_accvgpr_write_b32 a42, 0
    v_accvgpr_write_b32 a43, 0
    v_accvgpr_write_b32 a44, 0
    v_accvgpr_write_b32 a45, 0
    v_accvgpr_write_b32 a46, 0
    v_accvgpr_write_b32 a47, 0
    v_accvgpr_write_b32 a48, 0
    v_accvgpr_write_b32 a49, 0
    v_accvgpr_write_b32 a50, 0
    v_accvgpr_write_b32 a51, 0
    v_accvgpr_write_b32 a52, 0
    v_accvgpr_write_b32 a53, 0
    v_accvgpr_write_b32 a54, 0
    v_accvgpr_write_b32 a55, 0
    v_accvgpr_write_b32 a56, 0
    v_accvgpr_write_b32 a57, 0
    v_accvgpr_write_b32 a58, 0
    v_accvgpr_write_b32 a59, 0
    v_accvgpr_write_b32 a60, 0
    v_accvgpr_write_b32 a61, 0
    v_accvgpr_write_b32 a62, 0
    v_accvgpr_write_b32 a63, 0
    s_mov_b32 s40, 0
    s_mov_b32 s41, 0
    s_mul_i32 s42, s14, 4096
    s_add_u32 m0, s42, 0
    s_nop 0
    buffer_load_dwordx4 v6, s[20:23], s40 offen offset:0 lds
    s_mul_i32 s42, s14, 4096
    s_add_u32 m0, s42, 1024
    s_nop 0
    buffer_load_dwordx4 v9, s[20:23], s40 offen offset:0 lds
    s_mul_i32 s42, s14, 4096
    s_add_u32 m0, s42, 2048
    s_nop 0
    buffer_load_dwordx4 v11, s[20:23], s40 offen offset:0 lds
    s_mul_i32 s42, s14, 4096
    s_add_u32 m0, s42, 3072
    s_nop 0
    buffer_load_dwordx4 v12, s[20:23], s40 offen offset:0 lds
    s_mul_i32 s42, s14, 2048
    s_add_u32 m0, s42, 16384
    s_nop 0
    buffer_load_dwordx4 v7, s[24:27], s41 offen offset:0 lds
    s_mul_i32 s42, s14, 2048
    s_add_u32 m0, s42, 17408
    s_nop 0
    buffer_load_dwordx4 v10, s[24:27], s41 offen offset:0 lds
    s_mul_i32 s42, s14, 2048
    s_add_u32 m0, s42, 24576
    s_nop 0
    buffer_load_dwordx4 v7, s[28:31], s41 offen offset:0 lds
    s_mul_i32 s42, s14, 2048
    s_add_u32 m0, s42, 25600
    s_nop 0
    buffer_load_dwordx4 v10, s[28:31], s41 offen offset:0 lds
    s_add_u32 s40, s40, 128
    s_add_u32 s41, s41, 229376
    s_mul_i32 s42, s14, 4096
    s_add_u32 m0, s42, 32768
    s_nop 0
    buffer_load_dwordx4 v6, s[20:23], s40 offen offset:0 lds
    s_mul_i32 s42, s14, 4096
    s_add_u32 m0, s42, 33792
    s_nop 0
    buffer_load_dwordx4 v9, s[20:23], s40 offen offset:0 lds
    s_mul_i32 s42, s14, 4096
    s_add_u32 m0, s42, 34816
    s_nop 0
    buffer_load_dwordx4 v11, s[20:23], s40 offen offset:0 lds
    s_mul_i32 s42, s14, 4096
    s_add_u32 m0, s42, 35840
    s_nop 0
    buffer_load_dwordx4 v12, s[20:23], s40 offen offset:0 lds
    s_mul_i32 s42, s14, 2048
    s_add_u32 m0, s42, 49152
    s_nop 0
    buffer_load_dwordx4 v7, s[24:27], s41 offen offset:0 lds
    s_mul_i32 s42, s14, 2048
    s_add_u32 m0, s42, 50176
    s_nop 0
    buffer_load_dwordx4 v10, s[24:27], s41 offen offset:0 lds
    s_mul_i32 s42, s14, 2048
    s_add_u32 m0, s42, 57344
    s_nop 0
    buffer_load_dwordx4 v7, s[28:31], s41 offen offset:0 lds
    s_mul_i32 s42, s14, 2048
    s_add_u32 m0, s42, 58368
    s_nop 0
    buffer_load_dwordx4 v10, s[28:31], s41 offen offset:0 lds
    s_add_u32 s40, s40, 128
    s_add_u32 s41, s41, 229376
    s_waitcnt vmcnt(8)
    s_barrier
    ds_read_b128 v[32:35], v20 offset:0
    ds_read_b128 v[36:39], v20 offset:4096
    ds_read_b64_tr_b16 v[40:41], v24 offset:16384
    ds_read_b64_tr_b16 v[42:43], v24 offset:16896
    ds_read_b64_tr_b16 v[44:45], v24 offset:24576
    ds_read_b64_tr_b16 v[46:47], v24 offset:25088
    s_waitcnt lgkmcnt(0)
    v_mfma_f32_32x32x16_bf16 a[0:15], v[40:43], v[32:35], a[0:15]
    v_mfma_f32_32x32x16_bf16 a[16:31], v[44:47], v[32:35], a[16:31]
    v_mfma_f32_32x32x16_bf16 a[32:47], v[40:43], v[36:39], a[32:47]
    v_mfma_f32_32x32x16_bf16 a[48:63], v[44:47], v[36:39], a[48:63]
    ds_read_b128 v[32:35], v21 offset:0
    ds_read_b128 v[36:39], v21 offset:4096
    ds_read_b64_tr_b16 v[40:41], v24 offset:18432
    ds_read_b64_tr_b16 v[42:43], v24 offset:18944
    ds_read_b64_tr_b16 v[44:45], v24 offset:26624
    ds_read_b64_tr_b16 v[46:47], v24 offset:27136
    s_waitcnt lgkmcnt(0)
    v_mfma_f32_32x32x16_bf16 a[0:15], v[40:43], v[32:35], a[0:15]
    v_mfma_f32_32x32x16_bf16 a[16:31], v[44:47], v[32:35], a[16:31]
    v_mfma_f32_32x32x16_bf16 a[32:47], v[40:43], v[36:39], a[32:47]
    v_mfma_f32_32x32x16_bf16 a[48:63], v[44:47], v[36:39], a[48:63]
    ds_read_b128 v[32:35], v22 offset:0
    ds_read_b128 v[36:39], v22 offset:4096
    ds_read_b64_tr_b16 v[40:41], v24 offset:20480
    ds_read_b64_tr_b16 v[42:43], v24 offset:20992
    ds_read_b64_tr_b16 v[44:45], v24 offset:28672
    ds_read_b64_tr_b16 v[46:47], v24 offset:29184
    s_waitcnt lgkmcnt(0)
    v_mfma_f32_32x32x16_bf16 a[0:15], v[40:43], v[32:35], a[0:15]
    v_mfma_f32_32x32x16_bf16 a[16:31], v[44:47], v[32:35], a[16:31]
    v_mfma_f32_32x32x16_bf16 a[32:47], v[40:43], v[36:39], a[32:47]
    v_mfma_f32_32x32x16_bf16 a[48:63], v[44:47], v[36:39], a[48:63]
    ds_read_b128 v[32:35], v23 offset:0
    ds_read_b128 v[36:39], v23 offset:4096
    ds_read_b64_tr_b16 v[40:41], v24 offset:22528
    ds_read_b64_tr_b16 v[42:43], v24 offset:23040
    ds_read_b64_tr_b16 v[44:45], v24 offset:30720
    ds_read_b64_tr_b16 v[46:47], v24 offset:31232
    s_waitcnt lgkmcnt(0)
    v_mfma_f32_32x32x16_bf16 a[0:15], v[40:43], v[32:35], a[0:15]
    v_mfma_f32_32x32x16_bf16 a[16:31], v[44:47], v[32:35], a[16:31]
    v_mfma_f32_32x32x16_bf16 a[32:47], v[40:43], v[36:39], a[32:47]
    v_mfma_f32_32x32x16_bf16 a[48:63], v[44:47], v[36:39], a[48:63]
    s_barrier
    s_mul_i32 s42, s14, 4096
    s_add_u32 m0, s42, 0
    s_nop 0
    buffer_load_dwordx4 v6, s[20:23], s40 offen offset:0 lds
    s_mul_i32 s42, s14, 4096
    s_add_u32 m0, s42, 1024
    s_nop 0
    buffer_load_dwordx4 v9, s[20:23], s40 offen offset:0 lds
    s_mul_i32 s42, s14, 4096
    s_add_u32 m0, s42, 2048
    s_nop 0
    buffer_load_dwordx4 v11, s[20:23], s40 offen offset:0 lds
    s_mul_i32 s42, s14, 4096
    s_add_u32 m0, s42, 3072
    s_nop 0
    buffer_load_dwordx4 v12, s[20:23], s40 offen offset:0 lds
    s_mul_i32 s42, s14, 2048
    s_add_u32 m0, s42, 16384
    s_nop 0
    buffer_load_dwordx4 v7, s[24:27], s41 offen offset:0 lds
    s_mul_i32 s42, s14, 2048
    s_add_u32 m0, s42, 17408
    s_nop 0
    buffer_load_dwordx4 v10, s[24:27], s41 offen offset:0 lds
    s_mul_i32 s42, s14, 2048
    s_add_u32 m0, s42, 24576
    s_nop 0
    buffer_load_dwordx4 v7, s[28:31], s41 offen offset:0 lds
    s_mul_i32 s42, s14, 2048
    s_add_u32 m0, s42, 25600
    s_nop 0
    buffer_load_dwordx4 v10, s[28:31], s41 offen offset:0 lds
    s_add_u32 s40, s40, 128
    s_add_u32 s41, s41, 229376
    s_waitcnt vmcnt(8)
    s_barrier
    ds_read_b128 v[32:35], v20 offset:32768
    ds_read_b128 v[36:39], v20 offset:36864
    ds_read_b64_tr_b16 v[40:41], v24 offset:49152
    ds_read_b64_tr_b16 v[42:43], v24 offset:49664
    ds_read_b64_tr_b16 v[44:45], v24 offset:57344
    ds_read_b64_tr_b16 v[46:47], v24 offset:57856
    s_waitcnt lgkmcnt(0)
    v_mfma_f32_32x32x16_bf16 a[0:15], v[40:43], v[32:35], a[0:15]
    v_mfma_f32_32x32x16_bf16 a[16:31], v[44:47], v[32:35], a[16:31]
    v_mfma_f32_32x32x16_bf16 a[32:47], v[40:43], v[36:39], a[32:47]
    v_mfma_f32_32x32x16_bf16 a[48:63], v[44:47], v[36:39], a[48:63]
    ds_read_b128 v[32:35], v21 offset:32768
    ds_read_b128 v[36:39], v21 offset:36864
    ds_read_b64_tr_b16 v[40:41], v24 offset:51200
    ds_read_b64_tr_b16 v[42:43], v24 offset:51712
    ds_read_b64_tr_b16 v[44:45], v24 offset:59392
    ds_read_b64_tr_b16 v[46:47], v24 offset:59904
    s_waitcnt lgkmcnt(0)
    v_mfma_f32_32x32x16_bf16 a[0:15], v[40:43], v[32:35], a[0:15]
    v_mfma_f32_32x32x16_bf16 a[16:31], v[44:47], v[32:35], a[16:31]
    v_mfma_f32_32x32x16_bf16 a[32:47], v[40:43], v[36:39], a[32:47]
    v_mfma_f32_32x32x16_bf16 a[48:63], v[44:47], v[36:39], a[48:63]
    ds_read_b128 v[32:35], v22 offset:32768
    ds_read_b128 v[36:39], v22 offset:36864
    ds_read_b64_tr_b16 v[40:41], v24 offset:53248
    ds_read_b64_tr_b16 v[42:43], v24 offset:53760
    ds_read_b64_tr_b16 v[44:45], v24 offset:61440
    ds_read_b64_tr_b16 v[46:47], v24 offset:61952
    s_waitcnt lgkmcnt(0)
    v_mfma_f32_32x32x16_bf16 a[0:15], v[40:43], v[32:35], a[0:15]
    v_mfma_f32_32x32x16_bf16 a[16:31], v[44:47], v[32:35], a[16:31]
    v_mfma_f32_32x32x16_bf16 a[32:47], v[40:43], v[36:39], a[32:47]
    v_mfma_f32_32x32x16_bf16 a[48:63], v[44:47], v[36:39], a[48:63]
    ds_read_b128 v[32:35], v23 offset:32768
    ds_read_b128 v[36:39], v23 offset:36864
    ds_read_b64_tr_b16 v[40:41], v24 offset:55296
    ds_read_b64_tr_b16 v[42:43], v24 offset:55808
    ds_read_b64_tr_b16 v[44:45], v24 offset:63488
    ds_read_b64_tr_b16 v[46:47], v24 offset:64000
    s_waitcnt lgkmcnt(0)
    v_mfma_f32_32x32x16_bf16 a[0:15], v[40:43], v[32:35], a[0:15]
    v_mfma_f32_32x32x16_bf16 a[16:31], v[44:47], v[32:35], a[16:31]
    v_mfma_f32_32x32x16_bf16 a[32:47], v[40:43], v[36:39], a[32:47]
    v_mfma_f32_32x32x16_bf16 a[48:63], v[44:47], v[36:39], a[48:63]
    s_barrier
    s_mul_i32 s42, s14, 4096
    s_add_u32 m0, s42, 32768
    s_nop 0
    buffer_load_dwordx4 v6, s[20:23], s40 offen offset:0 lds
    s_mul_i32 s42, s14, 4096
    s_add_u32 m0, s42, 33792
    s_nop 0
    buffer_load_dwordx4 v9, s[20:23], s40 offen offset:0 lds
    s_mul_i32 s42, s14, 4096
    s_add_u32 m0, s42, 34816
    s_nop 0
    buffer_load_dwordx4 v11, s[20:23], s40 offen offset:0 lds
    s_mul_i32 s42, s14, 4096
    s_add_u32 m0, s42, 35840
    s_nop 0
    buffer_load_dwordx4 v12, s[20:23], s40 offen offset:0 lds
    s_mul_i32 s42, s14, 2048
    s_add_u32 m0, s42, 49152
    s_nop 0
    buffer_load_dwordx4 v7, s[24:27], s41 offen offset:0 lds
    s_mul_i32 s42, s14, 2048
    s_add_u32 m0, s42, 50176
    s_nop 0
    buffer_load_dwordx4 v10, s[24:27], s41 offen offset:0 lds
    s_mul_i32 s42, s14, 2048
    s_add_u32 m0, s42, 57344
    s_nop 0
    buffer_load_dwordx4 v7, s[28:31], s41 offen offset:0 lds
    s_mul_i32 s42, s14, 2048
    s_add_u32 m0, s42, 58368
    s_nop 0
    buffer_load_dwordx4 v10, s[28:31], s41 offen offset:0 lds
    s_add_u32 s40, s40, 128
    s_add_u32 s41, s41, 229376
    s_waitcnt vmcnt(8)
    s_barrier
    ds_read_b128 v[32:35], v20 offset:0
    ds_read_b128 v[36:39], v20 offset:4096
    ds_read_b64_tr_b16 v[40:41], v24 offset:16384
    ds_read_b64_tr_b16 v[42:43], v24 offset:16896
    ds_read_b64_tr_b16 v[44:45], v24 offset:24576
    ds_read_b64_tr_b16 v[46:47], v24 offset:25088
    s_waitcnt lgkmcnt(0)
    v_mfma_f32_32x32x16_bf16 a[0:15], v[40:43], v[32:35], a[0:15]
    v_mfma_f32_32x32x16_bf16 a[16:31], v[44:47], v[32:35], a[16:31]
    v_mfma_f32_32x32x16_bf16 a[32:47], v[40:43], v[36:39], a[32:47]
    v_mfma_f32_32x32x16_bf16 a[48:63], v[44:47], v[36:39], a[48:63]
    ds_read_b128 v[32:35], v21 offset:0
    ds_read_b128 v[36:39], v21 offset:4096
    ds_read_b64_tr_b16 v[40:41], v24 offset:18432
    ds_read_b64_tr_b16 v[42:43], v24 offset:18944
    ds_read_b64_tr_b16 v[44:45], v24 offset:26624
    ds_read_b64_tr_b16 v[46:47], v24 offset:27136
    s_waitcnt lgkmcnt(0)
    v_mfma_f32_32x32x16_bf16 a[0:15], v[40:43], v[32:35], a[0:15]
    v_mfma_f32_32x32x16_bf16 a[16:31], v[44:47], v[32:35], a[16:31]
    v_mfma_f32_32x32x16_bf16 a[32:47], v[40:43], v[36:39], a[32:47]
    v_mfma_f32_32x32x16_bf16 a[48:63], v[44:47], v[36:39], a[48:63]
    ds_read_b128 v[32:35], v22 offset:0
    ds_read_b128 v[36:39], v22 offset:4096
    ds_read_b64_tr_b16 v[40:41], v24 offset:20480
    ds_read_b64_tr_b16 v[42:43], v24 offset:20992
    ds_read_b64_tr_b16 v[44:45], v24 offset:28672
    ds_read_b64_tr_b16 v[46:47], v24 offset:29184
    s_waitcnt lgkmcnt(0)
    v_mfma_f32_32x32x16_bf16 a[0:15], v[40:43], v[32:35], a[0:15]
    v_mfma_f32_32x32x16_bf16 a[16:31], v[44:47], v[32:35], a[16:31]
    v_mfma_f32_32x32x16_bf16 a[32:47], v[40:43], v[36:39], a[32:47]
    v_mfma_f32_32x32x16_bf16 a[48:63], v[44:47], v[36:39], a[48:63]
    ds_read_b128 v[32:35], v23 offset:0
    ds_read_b128 v[36:39], v23 offset:4096
    ds_read_b64_tr_b16 v[40:41], v24 offset:22528
    ds_read_b64_tr_b16 v[42:43], v24 offset:23040
    ds_read_b64_tr_b16 v[44:45], v24 offset:30720
    ds_read_b64_tr_b16 v[46:47], v24 offset:31232
    s_waitcnt lgkmcnt(0)
    v_mfma_f32_32x32x16_bf16 a[0:15], v[40:43], v[32:35], a[0:15]
    v_mfma_f32_32x32x16_bf16 a[16:31], v[44:47], v[32:35], a[16:31]
    v_mfma_f32_32x32x16_bf16 a[32:47], v[40:43], v[36:39], a[32:47]
    v_mfma_f32_32x32x16_bf16 a[48:63], v[44:47], v[36:39], a[48:63]
    s_barrier
    s_mul_i32 s42, s14, 4096
    s_add_u32 m0, s42, 0
    s_nop 0
    buffer_load_dwordx4 v6, s[20:23], s40 offen offset:0 lds
    s_mul_i32 s42, s14, 4096
    s_add_u32 m0, s42, 1024
    s_nop 0
    buffer_load_dwordx4 v9, s[20:23], s40 offen offset:0 lds
    s_mul_i32 s42, s14, 4096
    s_add_u32 m0, s42, 2048
    s_nop 0
    buffer_load_dwordx4 v11, s[20:23], s40 offen offset:0 lds
    s_mul_i32 s42, s14, 4096
    s_add_u32 m0, s42, 3072
    s_nop 0
    buffer_load_dwordx4 v12, s[20:23], s40 offen offset:0 lds
    s_mul_i32 s42, s14, 2048
    s_add_u32 m0, s42, 16384
    s_nop 0
    buffer_load_dwordx4 v7, s[24:27], s41 offen offset:0 lds
    s_mul_i32 s42, s14, 2048
    s_add_u32 m0, s42, 17408
    s_nop 0
    buffer_load_dwordx4 v10, s[24:27], s41 offen offset:0 lds
    s_mul_i32 s42, s14, 2048
    s_add_u32 m0, s42, 24576
    s_nop 0
    buffer_load_dwordx4 v7, s[28:31], s41 offen offset:0 lds
    s_mul_i32 s42, s14, 2048
    s_add_u32 m0, s42, 25600
    s_nop 0
    buffer_load_dwordx4 v10, s[28:31], s41 offen offset:0 lds
    s_add_u32 s40, s40, 128
    s_add_u32 s41, s41, 229376
    s_waitcnt vmcnt(8)
    s_barrier
    ds_read_b128 v[32:35], v20 offset:32768
    ds_read_b128 v[36:39], v20 offset:36864
    ds_read_b64_tr_b16 v[40:41], v24 offset:49152
    ds_read_b64_tr_b16 v[42:43], v24 offset:49664
    ds_read_b64_tr_b16 v[44:45], v24 offset:57344
    ds_read_b64_tr_b16 v[46:47], v24 offset:57856
    s_waitcnt lgkmcnt(0)
    v_mfma_f32_32x32x16_bf16 a[0:15], v[40:43], v[32:35], a[0:15]
    v_mfma_f32_32x32x16_bf16 a[16:31], v[44:47], v[32:35], a[16:31]
    v_mfma_f32_32x32x16_bf16 a[32:47], v[40:43], v[36:39], a[32:47]
    v_mfma_f32_32x32x16_bf16 a[48:63], v[44:47], v[36:39], a[48:63]
    ds_read_b128 v[32:35], v21 offset:32768
    ds_read_b128 v[36:39], v21 offset:36864
    ds_read_b64_tr_b16 v[40:41], v24 offset:51200
    ds_read_b64_tr_b16 v[42:43], v24 offset:51712
    ds_read_b64_tr_b16 v[44:45], v24 offset:59392
    ds_read_b64_tr_b16 v[46:47], v24 offset:59904
    s_waitcnt lgkmcnt(0)
    v_mfma_f32_32x32x16_bf16 a[0:15], v[40:43], v[32:35], a[0:15]
    v_mfma_f32_32x32x16_bf16 a[16:31], v[44:47], v[32:35], a[16:31]
    v_mfma_f32_32x32x16_bf16 a[32:47], v[40:43], v[36:39], a[32:47]
    v_mfma_f32_32x32x16_bf16 a[48:63], v[44:47], v[36:39], a[48:63]
    ds_read_b128 v[32:35], v22 offset:32768
    ds_read_b128 v[36:39], v22 offset:36864
    ds_read_b64_tr_b16 v[40:41], v24 offset:53248
    ds_read_b64_tr_b16 v[42:43], v24 offset:53760
    ds_read_b64_tr_b16 v[44:45], v24 offset:61440
    ds_read_b64_tr_b16 v[46:47], v24 offset:61952
    s_waitcnt lgkmcnt(0)
    v_mfma_f32_32x32x16_bf16 a[0:15], v[40:43], v[32:35], a[0:15]
    v_mfma_f32_32x32x16_bf16 a[16:31], v[44:47], v[32:35], a[16:31]
    v_mfma_f32_32x32x16_bf16 a[32:47], v[40:43], v[36:39], a[32:47]
    v_mfma_f32_32x32x16_bf16 a[48:63], v[44:47], v[36:39], a[48:63]
    ds_read_b128 v[32:35], v23 offset:32768
    ds_read_b128 v[36:39], v23 offset:36864
    ds_read_b64_tr_b16 v[40:41], v24 offset:55296
    ds_read_b64_tr_b16 v[42:43], v24 offset:55808
    ds_read_b64_tr_b16 v[44:45], v24 offset:63488
    ds_read_b64_tr_b16 v[46:47], v24 offset:64000
    s_waitcnt lgkmcnt(0)
    v_mfma_f32_32x32x16_bf16 a[0:15], v[40:43], v[32:35], a[0:15]
    v_mfma_f32_32x32x16_bf16 a[16:31], v[44:47], v[32:35], a[16:31]
    v_mfma_f32_32x32x16_bf16 a[32:47], v[40:43], v[36:39], a[32:47]
    v_mfma_f32_32x32x16_bf16 a[48:63], v[44:47], v[36:39], a[48:63]
    s_barrier
    s_mul_i32 s42, s14, 4096
    s_add_u32 m0, s42, 32768
    s_nop 0
    buffer_load_dwordx4 v6, s[20:23], s40 offen offset:0 lds
    s_mul_i32 s42, s14, 4096
    s_add_u32 m0, s42, 33792
    s_nop 0
    buffer_load_dwordx4 v9, s[20:23], s40 offen offset:0 lds
    s_mul_i32 s42, s14, 4096
    s_add_u32 m0, s42, 34816
    s_nop 0
    buffer_load_dwordx4 v11, s[20:23], s40 offen offset:0 lds
    s_mul_i32 s42, s14, 4096
    s_add_u32 m0, s42, 35840
    s_nop 0
    buffer_load_dwordx4 v12, s[20:23], s40 offen offset:0 lds
    s_mul_i32 s42, s14, 2048
    s_add_u32 m0, s42, 49152
    s_nop 0
    buffer_load_dwordx4 v7, s[24:27], s41 offen offset:0 lds
    s_mul_i32 s42, s14, 2048
    s_add_u32 m0, s42, 50176
    s_nop 0
    buffer_load_dwordx4 v10, s[24:27], s41 offen offset:0 lds
    s_mul_i32 s42, s14, 2048
    s_add_u32 m0, s42, 57344
    s_nop 0
    buffer_load_dwordx4 v7, s[28:31], s41 offen offset:0 lds
    s_mul_i32 s42, s14, 2048
    s_add_u32 m0, s42, 58368
    s_nop 0
    buffer_load_dwordx4 v10, s[28:31], s41 offen offset:0 lds
    s_add_u32 s40, s40, 128
    s_add_u32 s41, s41, 229376
    s_waitcnt vmcnt(8)
    s_barrier
    ds_read_b128 v[32:35], v20 offset:0
    ds_read_b128 v[36:39], v20 offset:4096
    ds_read_b64_tr_b16 v[40:41], v24 offset:16384
    ds_read_b64_tr_b16 v[42:43], v24 offset:16896
    ds_read_b64_tr_b16 v[44:45], v24 offset:24576
    ds_read_b64_tr_b16 v[46:47], v24 offset:25088
    s_waitcnt lgkmcnt(0)
    v_mfma_f32_32x32x16_bf16 a[0:15], v[40:43], v[32:35], a[0:15]
    v_mfma_f32_32x32x16_bf16 a[16:31], v[44:47], v[32:35], a[16:31]
    v_mfma_f32_32x32x16_bf16 a[32:47], v[40:43], v[36:39], a[32:47]
    v_mfma_f32_32x32x16_bf16 a[48:63], v[44:47], v[36:39], a[48:63]
    ds_read_b128 v[32:35], v21 offset:0
    ds_read_b128 v[36:39], v21 offset:4096
    ds_read_b64_tr_b16 v[40:41], v24 offset:18432
    ds_read_b64_tr_b16 v[42:43], v24 offset:18944
    ds_read_b64_tr_b16 v[44:45], v24 offset:26624
    ds_read_b64_tr_b16 v[46:47], v24 offset:27136
    s_waitcnt lgkmcnt(0)
    v_mfma_f32_32x32x16_bf16 a[0:15], v[40:43], v[32:35], a[0:15]
    v_mfma_f32_32x32x16_bf16 a[16:31], v[44:47], v[32:35], a[16:31]
    v_mfma_f32_32x32x16_bf16 a[32:47], v[40:43], v[36:39], a[32:47]
    v_mfma_f32_32x32x16_bf16 a[48:63], v[44:47], v[36:39], a[48:63]
    ds_read_b128 v[32:35], v22 offset:0
    ds_read_b128 v[36:39], v22 offset:4096
    ds_read_b64_tr_b16 v[40:41], v24 offset:20480
    ds_read_b64_tr_b16 v[42:43], v24 offset:20992
    ds_read_b64_tr_b16 v[44:45], v24 offset:28672
    ds_read_b64_tr_b16 v[46:47], v24 offset:29184
    s_waitcnt lgkmcnt(0)
    v_mfma_f32_32x32x16_bf16 a[0:15], v[40:43], v[32:35], a[0:15]
    v_mfma_f32_32x32x16_bf16 a[16:31], v[44:47], v[32:35], a[16:31]
    v_mfma_f32_32x32x16_bf16 a[32:47], v[40:43], v[36:39], a[32:47]
    v_mfma_f32_32x32x16_bf16 a[48:63], v[44:47], v[36:39], a[48:63]
    ds_read_b128 v[32:35], v23 offset:0
    ds_read_b128 v[36:39], v23 offset:4096
    ds_read_b64_tr_b16 v[40:41], v24 offset:22528
    ds_read_b64_tr_b16 v[42:43], v24 offset:23040
    ds_read_b64_tr_b16 v[44:45], v24 offset:30720
    ds_read_b64_tr_b16 v[46:47], v24 offset:31232
    s_waitcnt lgkmcnt(0)
    v_mfma_f32_32x32x16_bf16 a[0:15], v[40:43], v[32:35], a[0:15]
    v_mfma_f32_32x32x16_bf16 a[16:31], v[44:47], v[32:35], a[16:31]
    v_mfma_f32_32x32x16_bf16 a[32:47], v[40:43], v[36:39], a[32:47]
    v_mfma_f32_32x32x16_bf16 a[48:63], v[44:47], v[36:39], a[48:63]
    s_barrier
    s_mul_i32 s42, s14, 4096
    s_add_u32 m0, s42, 0
    s_nop 0
    buffer_load_dwordx4 v6, s[20:23], s40 offen offset:0 lds
    s_mul_i32 s42, s14, 4096
    s_add_u32 m0, s42, 1024
    s_nop 0
    buffer_load_dwordx4 v9, s[20:23], s40 offen offset:0 lds
    s_mul_i32 s42, s14, 4096
    s_add_u32 m0, s42, 2048
    s_nop 0
    buffer_load_dwordx4 v11, s[20:23], s40 offen offset:0 lds
    s_mul_i32 s42, s14, 4096
    s_add_u32 m0, s42, 3072
    s_nop 0
    buffer_load_dwordx4 v12, s[20:23], s40 offen offset:0 lds
    s_mul_i32 s42, s14, 2048
    s_add_u32 m0, s42, 16384
    s_nop 0
    buffer_load_dwordx4 v7, s[24:27], s41 offen offset:0 lds
    s_mul_i32 s42, s14, 2048
    s_add_u32 m0, s42, 17408
    s_nop 0
    buffer_load_dwordx4 v10, s[24:27], s41 offen offset:0 lds
    s_mul_i32 s42, s14, 2048
    s_add_u32 m0, s42, 24576
    s_nop 0
    buffer_load_dwordx4 v7, s[28:31], s41 offen offset:0 lds
    s_mul_i32 s42, s14, 2048
    s_add_u32 m0, s42, 25600
    s_nop 0
    buffer_load_dwordx4 v10, s[28:31], s41 offen offset:0 lds
    s_add_u32 s40, s40, 128
    s_add_u32 s41, s41, 229376
    s_waitcnt vmcnt(8)
    s_barrier
    ds_read_b128 v[32:35], v20 offset:32768
    ds_read_b128 v[36:39], v20 offset:36864
    ds_read_b64_tr_b16 v[40:41], v24 offset:49152
    ds_read_b64_tr_b16 v[42:43], v24 offset:49664
    ds_read_b64_tr_b16 v[44:45], v24 offset:57344
    ds_read_b64_tr_b16 v[46:47], v24 offset:57856
    s_waitcnt lgkmcnt(0)
    v_mfma_f32_32x32x16_bf16 a[0:15], v[40:43], v[32:35], a[0:15]
    v_mfma_f32_32x32x16_bf16 a[16:31], v[44:47], v[32:35], a[16:31]
    v_mfma_f32_32x32x16_bf16 a[32:47], v[40:43], v[36:39], a[32:47]
    v_mfma_f32_32x32x16_bf16 a[48:63], v[44:47], v[36:39], a[48:63]
    ds_read_b128 v[32:35], v21 offset:32768
    ds_read_b128 v[36:39], v21 offset:36864
    ds_read_b64_tr_b16 v[40:41], v24 offset:51200
    ds_read_b64_tr_b16 v[42:43], v24 offset:51712
    ds_read_b64_tr_b16 v[44:45], v24 offset:59392
    ds_read_b64_tr_b16 v[46:47], v24 offset:59904
    s_waitcnt lgkmcnt(0)
    v_mfma_f32_32x32x16_bf16 a[0:15], v[40:43], v[32:35], a[0:15]
    v_mfma_f32_32x32x16_bf16 a[16:31], v[44:47], v[32:35], a[16:31]
    v_mfma_f32_32x32x16_bf16 a[32:47], v[40:43], v[36:39], a[32:47]
    v_mfma_f32_32x32x16_bf16 a[48:63], v[44:47], v[36:39], a[48:63]
    ds_read_b128 v[32:35], v22 offset:32768
    ds_read_b128 v[36:39], v22 offset:36864
    ds_read_b64_tr_b16 v[40:41], v24 offset:53248
    ds_read_b64_tr_b16 v[42:43], v24 offset:53760
    ds_read_b64_tr_b16 v[44:45], v24 offset:61440
    ds_read_b64_tr_b16 v[46:47], v24 offset:61952
    s_waitcnt lgkmcnt(0)
    v_mfma_f32_32x32x16_bf16 a[0:15], v[40:43], v[32:35], a[0:15]
    v_mfma_f32_32x32x16_bf16 a[16:31], v[44:47], v[32:35], a[16:31]
    v_mfma_f32_32x32x16_bf16 a[32:47], v[40:43], v[36:39], a[32:47]
    v_mfma_f32_32x32x16_bf16 a[48:63], v[44:47], v[36:39], a[48:63]
    ds_read_b128 v[32:35], v23 offset:32768
    ds_read_b128 v[36:39], v23 offset:36864
    ds_read_b64_tr_b16 v[40:41], v24 offset:55296
    ds_read_b64_tr_b16 v[42:43], v24 offset:55808
    ds_read_b64_tr_b16 v[44:45], v24 offset:63488
    ds_read_b64_tr_b16 v[46:47], v24 offset:64000
    s_waitcnt lgkmcnt(0)
    v_mfma_f32_32x32x16_bf16 a[0:15], v[40:43], v[32:35], a[0:15]
    v_mfma_f32_32x32x16_bf16 a[16:31], v[44:47], v[32:35], a[16:31]
    v_mfma_f32_32x32x16_bf16 a[32:47], v[40:43], v[36:39], a[32:47]
    v_mfma_f32_32x32x16_bf16 a[48:63], v[44:47], v[36:39], a[48:63]
    s_barrier
    s_mul_i32 s42, s14, 4096
    s_add_u32 m0, s42, 32768
    s_nop 0
    buffer_load_dwordx4 v6, s[20:23], s40 offen offset:0 lds
    s_mul_i32 s42, s14, 4096
    s_add_u32 m0, s42, 33792
    s_nop 0
    buffer_load_dwordx4 v9, s[20:23], s40 offen offset:0 lds
    s_mul_i32 s42, s14, 4096
    s_add_u32 m0, s42, 34816
    s_nop 0
    buffer_load_dwordx4 v11, s[20:23], s40 offen offset:0 lds
    s_mul_i32 s42, s14, 4096
    s_add_u32 m0, s42, 35840
    s_nop 0
    buffer_load_dwordx4 v12, s[20:23], s40 offen offset:0 lds
    s_mul_i32 s42, s14, 2048
    s_add_u32 m0, s42, 49152
    s_nop 0
    buffer_load_dwordx4 v7, s[24:27], s41 offen offset:0 lds
    s_mul_i32 s42, s14, 2048
    s_add_u32 m0, s42, 50176
    s_nop 0
    buffer_load_dwordx4 v10, s[24:27], s41 offen offset:0 lds
    s_mul_i32 s42, s14, 2048
    s_add_u32 m0, s42, 57344
    s_nop 0
    buffer_load_dwordx4 v7, s[28:31], s41 offen offset:0 lds
    s_mul_i32 s42, s14, 2048
    s_add_u32 m0, s42, 58368
    s_nop 0
    buffer_load_dwordx4 v10, s[28:31], s41 offen offset:0 lds
    s_add_u32 s40, s40, 128
    s_add_u32 s41, s41, 229376
    s_waitcnt vmcnt(8)
    s_barrier
    ds_read_b128 v[32:35], v20 offset:0
    ds_read_b128 v[36:39], v20 offset:4096
    ds_read_b64_tr_b16 v[40:41], v24 offset:16384
    ds_read_b64_tr_b16 v[42:43], v24 offset:16896
    ds_read_b64_tr_b16 v[44:45], v24 offset:24576
    ds_read_b64_tr_b16 v[46:47], v24 offset:25088
    s_waitcnt lgkmcnt(0)
    v_mfma_f32_32x32x16_bf16 a[0:15], v[40:43], v[32:35], a[0:15]
    v_mfma_f32_32x32x16_bf16 a[16:31], v[44:47], v[32:35], a[16:31]
    v_mfma_f32_32x32x16_bf16 a[32:47], v[40:43], v[36:39], a[32:47]
    v_mfma_f32_32x32x16_bf16 a[48:63], v[44:47], v[36:39], a[48:63]
    ds_read_b128 v[32:35], v21 offset:0
    ds_read_b128 v[36:39], v21 offset:4096
    ds_read_b64_tr_b16 v[40:41], v24 offset:18432
    ds_read_b64_tr_b16 v[42:43], v24 offset:18944
    ds_read_b64_tr_b16 v[44:45], v24 offset:26624
    ds_read_b64_tr_b16 v[46:47], v24 offset:27136
    s_waitcnt lgkmcnt(0)
    v_mfma_f32_32x32x16_bf16 a[0:15], v[40:43], v[32:35], a[0:15]
    v_mfma_f32_32x32x16_bf16 a[16:31], v[44:47], v[32:35], a[16:31]
    v_mfma_f32_32x32x16_bf16 a[32:47], v[40:43], v[36:39], a[32:47]
    v_mfma_f32_32x32x16_bf16 a[48:63], v[44:47], v[36:39], a[48:63]
    ds_read_b128 v[32:35], v22 offset:0
    ds_read_b128 v[36:39], v22 offset:4096
    ds_read_b64_tr_b16 v[40:41], v24 offset:20480
    ds_read_b64_tr_b16 v[42:43], v24 offset:20992
    ds_read_b64_tr_b16 v[44:45], v24 offset:28672
    ds_read_b64_tr_b16 v[46:47], v24 offset:29184
    s_waitcnt lgkmcnt(0)
    v_mfma_f32_32x32x16_bf16 a[0:15], v[40:43], v[32:35], a[0:15]
    v_mfma_f32_32x32x16_bf16 a[16:31], v[44:47], v[32:35], a[16:31]
    v_mfma_f32_32x32x16_bf16 a[32:47], v[40:43], v[36:39], a[32:47]
    v_mfma_f32_32x32x16_bf16 a[48:63], v[44:47], v[36:39], a[48:63]
    ds_read_b128 v[32:35], v23 offset:0
    ds_read_b128 v[36:39], v23 offset:4096
    ds_read_b64_tr_b16 v[40:41], v24 offset:22528
    ds_read_b64_tr_b16 v[42:43], v24 offset:23040
    ds_read_b64_tr_b16 v[44:45], v24 offset:30720
    ds_read_b64_tr_b16 v[46:47], v24 offset:31232
    s_waitcnt lgkmcnt(0)
    v_mfma_f32_32x32x16_bf16 a[0:15], v[40:43], v[32:35], a[0:15]
    v_mfma_f32_32x32x16_bf16 a[16:31], v[44:47], v[32:35], a[16:31]
    v_mfma_f32_32x32x16_bf16 a[32:47], v[40:43], v[36:39], a[32:47]
    v_mfma_f32_32x32x16_bf16 a[48:63], v[44:47], v[36:39], a[48:63]
    s_barrier
    s_waitcnt vmcnt(0)
    s_barrier
    ds_read_b128 v[32:35], v20 offset:32768
    ds_read_b128 v[36:39], v20 offset:36864
    ds_read_b64_tr_b16 v[40:41], v24 offset:49152
    ds_read_b64_tr_b16 v[42:43], v24 offset:49664
    ds_read_b64_tr_b16 v[44:45], v24 offset:57344
    ds_read_b64_tr_b16 v[46:47], v24 offset:57856
    s_waitcnt lgkmcnt(0)
    v_mfma_f32_32x32x16_bf16 a[0:15], v[40:43], v[32:35], a[0:15]
    v_mfma_f32_32x32x16_bf16 a[16:31], v[44:47], v[32:35], a[16:31]
    v_mfma_f32_32x32x16_bf16 a[32:47], v[40:43], v[36:39], a[32:47]
    v_mfma_f32_32x32x16_bf16 a[48:63], v[44:47], v[36:39], a[48:63]
    ds_read_b128 v[32:35], v21 offset:32768
    ds_read_b128 v[36:39], v21 offset:36864
    ds_read_b64_tr_b16 v[40:41], v24 offset:51200
    ds_read_b64_tr_b16 v[42:43], v24 offset:51712
    ds_read_b64_tr_b16 v[44:45], v24 offset:59392
    ds_read_b64_tr_b16 v[46:47], v24 offset:59904
    s_waitcnt lgkmcnt(0)
    v_mfma_f32_32x32x16_bf16 a[0:15], v[40:43], v[32:35], a[0:15]
    v_mfma_f32_32x32x16_bf16 a[16:31], v[44:47], v[32:35], a[16:31]
    v_mfma_f32_32x32x16_bf16 a[32:47], v[40:43], v[36:39], a[32:47]
    v_mfma_f32_32x32x16_bf16 a[48:63], v[44:47], v[36:39], a[48:63]
    ds_read_b128 v[32:35], v22 offset:32768
    ds_read_b128 v[36:39], v22 offset:36864
    ds_read_b64_tr_b16 v[40:41], v24 offset:53248
    ds_read_b64_tr_b16 v[42:43], v24 offset:53760
    ds_read_b64_tr_b16 v[44:45], v24 offset:61440
    ds_read_b64_tr_b16 v[46:47], v24 offset:61952
    s_waitcnt lgkmcnt(0)
    v_mfma_f32_32x32x16_bf16 a[0:15], v[40:43], v[32:35], a[0:15]
    v_mfma_f32_32x32x16_bf16 a[16:31], v[44:47], v[32:35], a[16:31]
    v_mfma_f32_32x32x16_bf16 a[32:47], v[40:43], v[36:39], a[32:47]
    v_mfma_f32_32x32x16_bf16 a[48:63], v[44:47], v[36:39], a[48:63]
    ds_read_b128 v[32:35], v23 offset:32768
    ds_read_b128 v[36:39], v23 offset:36864
    ds_read_b64_tr_b16 v[40:41], v24 offset:55296
    ds_read_b64_tr_b16 v[42:43], v24 offset:55808
    ds_read_b64_tr_b16 v[44:45], v24 offset:63488
    ds_read_b64_tr_b16 v[46:47], v24 offset:64000
    s_waitcnt lgkmcnt(0)
    v_mfma_f32_32x32x16_bf16 a[0:15], v[40:43], v[32:35], a[0:15]
    v_mfma_f32_32x32x16_bf16 a[16:31], v[44:47], v[32:35], a[16:31]
    v_mfma_f32_32x32x16_bf16 a[32:47], v[40:43], v[36:39], a[32:47]
    v_mfma_f32_32x32x16_bf16 a[48:63], v[44:47], v[36:39], a[48:63]
    s_barrier
    s_nop 15
    s_lshl_b32 s43, s15, 7
    s_lshl_b32 s44, s35, 6
    s_add_u32 s43, s43, s44
    v_add_u32 v50, s43, v13
    v_mul_u32_u24 v50, 3584, v50
    s_lshl_b32 s44, s16, 7
    s_lshl_b32 s45, s36, 6
    s_add_u32 s44, s44, s45
    v_lshlrev_b32 v51, 3, v14
    v_add3_u32 v50, v50, v51, s44

    s_add_u32 s18, s12, 8388608
    s_addc_u32 s19, s13, 0
    s_mov_b32 s20, s18
    s_and_b32 s21, s19, 0xffff
    s_mov_b32 s22, 7340032
    s_mov_b32 s23, 0x00020000

    v_accvgpr_read_b32 v52, a0
    v_accvgpr_read_b32 v56, a16
    v_accvgpr_read_b32 v53, a1
    v_accvgpr_read_b32 v57, a17
    v_accvgpr_read_b32 v54, a2
    v_accvgpr_read_b32 v58, a18
    v_accvgpr_read_b32 v55, a3
    v_accvgpr_read_b32 v59, a19
    v_cvt_pk_bf16_f32 v52, v52, v52
    v_lshlrev_b32 v52, 16, v52
    v_cvt_pk_bf16_f32 v56, v56, v56
    v_lshlrev_b32 v56, 16, v56
    v_max_f32 v52, 0, v52
    v_mul_f32 v52, v52, v56
    v_cvt_pk_bf16_f32 v53, v53, v53
    v_lshlrev_b32 v53, 16, v53
    v_cvt_pk_bf16_f32 v57, v57, v57
    v_lshlrev_b32 v57, 16, v57
    v_max_f32 v53, 0, v53
    v_mul_f32 v53, v53, v57
    v_cvt_pk_bf16_f32 v54, v54, v54
    v_lshlrev_b32 v54, 16, v54
    v_cvt_pk_bf16_f32 v58, v58, v58
    v_lshlrev_b32 v58, 16, v58
    v_max_f32 v54, 0, v54
    v_mul_f32 v54, v54, v58
    v_cvt_pk_bf16_f32 v55, v55, v55
    v_lshlrev_b32 v55, 16, v55
    v_cvt_pk_bf16_f32 v59, v59, v59
    v_lshlrev_b32 v59, 16, v59
    v_max_f32 v55, 0, v55
    v_mul_f32 v55, v55, v59
    v_cvt_pk_bf16_f32 v60, v52, v53
    v_cvt_pk_bf16_f32 v61, v54, v55
    buffer_store_dwordx2 v[60:61], v50, s[20:23], 0 offen offset:0
    v_accvgpr_read_b32 v52, a4
    v_accvgpr_read_b32 v56, a20
    v_accvgpr_read_b32 v53, a5
    v_accvgpr_read_b32 v57, a21
    v_accvgpr_read_b32 v54, a6
    v_accvgpr_read_b32 v58, a22
    v_accvgpr_read_b32 v55, a7
    v_accvgpr_read_b32 v59, a23
    v_cvt_pk_bf16_f32 v52, v52, v52
    v_lshlrev_b32 v52, 16, v52
    v_cvt_pk_bf16_f32 v56, v56, v56
    v_lshlrev_b32 v56, 16, v56
    v_max_f32 v52, 0, v52
    v_mul_f32 v52, v52, v56
    v_cvt_pk_bf16_f32 v53, v53, v53
    v_lshlrev_b32 v53, 16, v53
    v_cvt_pk_bf16_f32 v57, v57, v57
    v_lshlrev_b32 v57, 16, v57
    v_max_f32 v53, 0, v53
    v_mul_f32 v53, v53, v57
    v_cvt_pk_bf16_f32 v54, v54, v54
    v_lshlrev_b32 v54, 16, v54
    v_cvt_pk_bf16_f32 v58, v58, v58
    v_lshlrev_b32 v58, 16, v58
    v_max_f32 v54, 0, v54
    v_mul_f32 v54, v54, v58
    v_cvt_pk_bf16_f32 v55, v55, v55
    v_lshlrev_b32 v55, 16, v55
    v_cvt_pk_bf16_f32 v59, v59, v59
    v_lshlrev_b32 v59, 16, v59
    v_max_f32 v55, 0, v55
    v_mul_f32 v55, v55, v59
    v_cvt_pk_bf16_f32 v60, v52, v53
    v_cvt_pk_bf16_f32 v61, v54, v55
    buffer_store_dwordx2 v[60:61], v50, s[20:23], 0 offen offset:16
    v_accvgpr_read_b32 v52, a8
    v_accvgpr_read_b32 v56, a24
    v_accvgpr_read_b32 v53, a9
    v_accvgpr_read_b32 v57, a25
    v_accvgpr_read_b32 v54, a10
    v_accvgpr_read_b32 v58, a26
    v_accvgpr_read_b32 v55, a11
    v_accvgpr_read_b32 v59, a27
    v_cvt_pk_bf16_f32 v52, v52, v52
    v_lshlrev_b32 v52, 16, v52
    v_cvt_pk_bf16_f32 v56, v56, v56
    v_lshlrev_b32 v56, 16, v56
    v_max_f32 v52, 0, v52
    v_mul_f32 v52, v52, v56
    v_cvt_pk_bf16_f32 v53, v53, v53
    v_lshlrev_b32 v53, 16, v53
    v_cvt_pk_bf16_f32 v57, v57, v57
    v_lshlrev_b32 v57, 16, v57
    v_max_f32 v53, 0, v53
    v_mul_f32 v53, v53, v57
    v_cvt_pk_bf16_f32 v54, v54, v54
    v_lshlrev_b32 v54, 16, v54
    v_cvt_pk_bf16_f32 v58, v58, v58
    v_lshlrev_b32 v58, 16, v58
    v_max_f32 v54, 0, v54
    v_mul_f32 v54, v54, v58
    v_cvt_pk_bf16_f32 v55, v55, v55
    v_lshlrev_b32 v55, 16, v55
    v_cvt_pk_bf16_f32 v59, v59, v59
    v_lshlrev_b32 v59, 16, v59
    v_max_f32 v55, 0, v55
    v_mul_f32 v55, v55, v59
    v_cvt_pk_bf16_f32 v60, v52, v53
    v_cvt_pk_bf16_f32 v61, v54, v55
    buffer_store_dwordx2 v[60:61], v50, s[20:23], 0 offen offset:32
    v_accvgpr_read_b32 v52, a12
    v_accvgpr_read_b32 v56, a28
    v_accvgpr_read_b32 v53, a13
    v_accvgpr_read_b32 v57, a29
    v_accvgpr_read_b32 v54, a14
    v_accvgpr_read_b32 v58, a30
    v_accvgpr_read_b32 v55, a15
    v_accvgpr_read_b32 v59, a31
    v_cvt_pk_bf16_f32 v52, v52, v52
    v_lshlrev_b32 v52, 16, v52
    v_cvt_pk_bf16_f32 v56, v56, v56
    v_lshlrev_b32 v56, 16, v56
    v_max_f32 v52, 0, v52
    v_mul_f32 v52, v52, v56
    v_cvt_pk_bf16_f32 v53, v53, v53
    v_lshlrev_b32 v53, 16, v53
    v_cvt_pk_bf16_f32 v57, v57, v57
    v_lshlrev_b32 v57, 16, v57
    v_max_f32 v53, 0, v53
    v_mul_f32 v53, v53, v57
    v_cvt_pk_bf16_f32 v54, v54, v54
    v_lshlrev_b32 v54, 16, v54
    v_cvt_pk_bf16_f32 v58, v58, v58
    v_lshlrev_b32 v58, 16, v58
    v_max_f32 v54, 0, v54
    v_mul_f32 v54, v54, v58
    v_cvt_pk_bf16_f32 v55, v55, v55
    v_lshlrev_b32 v55, 16, v55
    v_cvt_pk_bf16_f32 v59, v59, v59
    v_lshlrev_b32 v59, 16, v59
    v_max_f32 v55, 0, v55
    v_mul_f32 v55, v55, v59
    v_cvt_pk_bf16_f32 v60, v52, v53
    v_cvt_pk_bf16_f32 v61, v54, v55
    buffer_store_dwordx2 v[60:61], v50, s[20:23], 0 offen offset:48
    v_add_u32 v50, 114688, v50
    v_accvgpr_read_b32 v52, a32
    v_accvgpr_read_b32 v56, a48
    v_accvgpr_read_b32 v53, a33
    v_accvgpr_read_b32 v57, a49
    v_accvgpr_read_b32 v54, a34
    v_accvgpr_read_b32 v58, a50
    v_accvgpr_read_b32 v55, a35
    v_accvgpr_read_b32 v59, a51
    v_cvt_pk_bf16_f32 v52, v52, v52
    v_lshlrev_b32 v52, 16, v52
    v_cvt_pk_bf16_f32 v56, v56, v56
    v_lshlrev_b32 v56, 16, v56
    v_max_f32 v52, 0, v52
    v_mul_f32 v52, v52, v56
    v_cvt_pk_bf16_f32 v53, v53, v53
    v_lshlrev_b32 v53, 16, v53
    v_cvt_pk_bf16_f32 v57, v57, v57
    v_lshlrev_b32 v57, 16, v57
    v_max_f32 v53, 0, v53
    v_mul_f32 v53, v53, v57
    v_cvt_pk_bf16_f32 v54, v54, v54
    v_lshlrev_b32 v54, 16, v54
    v_cvt_pk_bf16_f32 v58, v58, v58
    v_lshlrev_b32 v58, 16, v58
    v_max_f32 v54, 0, v54
    v_mul_f32 v54, v54, v58
    v_cvt_pk_bf16_f32 v55, v55, v55
    v_lshlrev_b32 v55, 16, v55
    v_cvt_pk_bf16_f32 v59, v59, v59
    v_lshlrev_b32 v59, 16, v59
    v_max_f32 v55, 0, v55
    v_mul_f32 v55, v55, v59
    v_cvt_pk_bf16_f32 v60, v52, v53
    v_cvt_pk_bf16_f32 v61, v54, v55
    buffer_store_dwordx2 v[60:61], v50, s[20:23], 0 offen offset:0
    v_accvgpr_read_b32 v52, a36
    v_accvgpr_read_b32 v56, a52
    v_accvgpr_read_b32 v53, a37
    v_accvgpr_read_b32 v57, a53
    v_accvgpr_read_b32 v54, a38
    v_accvgpr_read_b32 v58, a54
    v_accvgpr_read_b32 v55, a39
    v_accvgpr_read_b32 v59, a55
    v_cvt_pk_bf16_f32 v52, v52, v52
    v_lshlrev_b32 v52, 16, v52
    v_cvt_pk_bf16_f32 v56, v56, v56
    v_lshlrev_b32 v56, 16, v56
    v_max_f32 v52, 0, v52
    v_mul_f32 v52, v52, v56
    v_cvt_pk_bf16_f32 v53, v53, v53
    v_lshlrev_b32 v53, 16, v53
    v_cvt_pk_bf16_f32 v57, v57, v57
    v_lshlrev_b32 v57, 16, v57
    v_max_f32 v53, 0, v53
    v_mul_f32 v53, v53, v57
    v_cvt_pk_bf16_f32 v54, v54, v54
    v_lshlrev_b32 v54, 16, v54
    v_cvt_pk_bf16_f32 v58, v58, v58
    v_lshlrev_b32 v58, 16, v58
    v_max_f32 v54, 0, v54
    v_mul_f32 v54, v54, v58
    v_cvt_pk_bf16_f32 v55, v55, v55
    v_lshlrev_b32 v55, 16, v55
    v_cvt_pk_bf16_f32 v59, v59, v59
    v_lshlrev_b32 v59, 16, v59
    v_max_f32 v55, 0, v55
    v_mul_f32 v55, v55, v59
    v_cvt_pk_bf16_f32 v60, v52, v53
    v_cvt_pk_bf16_f32 v61, v54, v55
    buffer_store_dwordx2 v[60:61], v50, s[20:23], 0 offen offset:16
    v_accvgpr_read_b32 v52, a40
    v_accvgpr_read_b32 v56, a56
    v_accvgpr_read_b32 v53, a41
    v_accvgpr_read_b32 v57, a57
    v_accvgpr_read_b32 v54, a42
    v_accvgpr_read_b32 v58, a58
    v_accvgpr_read_b32 v55, a43
    v_accvgpr_read_b32 v59, a59
    v_cvt_pk_bf16_f32 v52, v52, v52
    v_lshlrev_b32 v52, 16, v52
    v_cvt_pk_bf16_f32 v56, v56, v56
    v_lshlrev_b32 v56, 16, v56
    v_max_f32 v52, 0, v52
    v_mul_f32 v52, v52, v56
    v_cvt_pk_bf16_f32 v53, v53, v53
    v_lshlrev_b32 v53, 16, v53
    v_cvt_pk_bf16_f32 v57, v57, v57
    v_lshlrev_b32 v57, 16, v57
    v_max_f32 v53, 0, v53
    v_mul_f32 v53, v53, v57
    v_cvt_pk_bf16_f32 v54, v54, v54
    v_lshlrev_b32 v54, 16, v54
    v_cvt_pk_bf16_f32 v58, v58, v58
    v_lshlrev_b32 v58, 16, v58
    v_max_f32 v54, 0, v54
    v_mul_f32 v54, v54, v58
    v_cvt_pk_bf16_f32 v55, v55, v55
    v_lshlrev_b32 v55, 16, v55
    v_cvt_pk_bf16_f32 v59, v59, v59
    v_lshlrev_b32 v59, 16, v59
    v_max_f32 v55, 0, v55
    v_mul_f32 v55, v55, v59
    v_cvt_pk_bf16_f32 v60, v52, v53
    v_cvt_pk_bf16_f32 v61, v54, v55
    buffer_store_dwordx2 v[60:61], v50, s[20:23], 0 offen offset:32
    v_accvgpr_read_b32 v52, a44
    v_accvgpr_read_b32 v56, a60
    v_accvgpr_read_b32 v53, a45
    v_accvgpr_read_b32 v57, a61
    v_accvgpr_read_b32 v54, a46
    v_accvgpr_read_b32 v58, a62
    v_accvgpr_read_b32 v55, a47
    v_accvgpr_read_b32 v59, a63
    v_cvt_pk_bf16_f32 v52, v52, v52
    v_lshlrev_b32 v52, 16, v52
    v_cvt_pk_bf16_f32 v56, v56, v56
    v_lshlrev_b32 v56, 16, v56
    v_max_f32 v52, 0, v52
    v_mul_f32 v52, v52, v56
    v_cvt_pk_bf16_f32 v53, v53, v53
    v_lshlrev_b32 v53, 16, v53
    v_cvt_pk_bf16_f32 v57, v57, v57
    v_lshlrev_b32 v57, 16, v57
    v_max_f32 v53, 0, v53
    v_mul_f32 v53, v53, v57
    v_cvt_pk_bf16_f32 v54, v54, v54
    v_lshlrev_b32 v54, 16, v54
    v_cvt_pk_bf16_f32 v58, v58, v58
    v_lshlrev_b32 v58, 16, v58
    v_max_f32 v54, 0, v54
    v_mul_f32 v54, v54, v58
    v_cvt_pk_bf16_f32 v55, v55, v55
    v_lshlrev_b32 v55, 16, v55
    v_cvt_pk_bf16_f32 v59, v59, v59
    v_lshlrev_b32 v59, 16, v59
    v_max_f32 v55, 0, v55
    v_mul_f32 v55, v55, v59
    v_cvt_pk_bf16_f32 v60, v52, v53
    v_cvt_pk_bf16_f32 v61, v54, v55
    buffer_store_dwordx2 v[60:61], v50, s[20:23], 0 offen offset:48
K4_END:
    s_endpgm
.globl k5_kernel
.p2align 8
.type k5_kernel,@function
k5_kernel:
    s_cmp_ge_u32 s2, 256
    s_cbranch_scc1 K5_END
    s_load_dwordx4 s[4:7], s[0:1], 56
    s_load_dwordx4 s[8:11], s[0:1], 72
    s_load_dwordx2 s[12:13], s[0:1], 96
    v_and_b32 v1, 63, v0
    v_lshrrev_b32 v2, 6, v0
    s_nop 0
    v_readfirstlane_b32 s14, v2
    s_and_b32 s15, s2, 31
    s_lshr_b32 s16, s2, 5
    s_waitcnt lgkmcnt(0)
    s_add_u32 s18, s12, 8388608
    s_addc_u32 s19, s13, 0

    s_mov_b32 s20, s18
    s_and_b32 s21, s19, 0xffff
    s_mov_b32 s22, 7340032
    s_mov_b32 s23, 0x00020000

    s_mov_b32 s24, s8
    s_and_b32 s25, s9, 0xffff
    s_mov_b32 s26, 1835008
    s_mov_b32 s27, 0x00020000

    v_lshrrev_b32 v3, 3, v1
    v_and_b32 v4, 7, v1
    v_xor_b32 v5, v4, v3
    v_lshlrev_b32 v5, 4, v5
    s_lshl_b32 s17, s15, 6
    s_lshl_b32 s32, s14, 4
    s_add_u32 s17, s17, s32
    v_add_u32 v6, s17, v3
    v_mul_u32_u24 v6, 3584, v6
    v_add_u32 v6, v6, v5
    v_lshrrev_b32 v7, 4, v1
    v_and_b32 v7, 1, v7
    v_lshlrev_b32 v7, 2, v7
    v_xor_b32 v7, v7, v4
    v_lshlrev_b32 v7, 4, v7
    s_lshl_b32 s33, s14, 5
    v_add_u32 v8, s33, v3
    v_mul_u32_u24 v8, 1024, v8
    s_lshl_b32 s34, s16, 7
    v_add3_u32 v7, v7, v8, s34
    v_add_u32 v9, 28672, v6
    v_add_u32 v10, 8192, v7

    v_add_u32 v11, 16384, v7
    v_add_u32 v12, 24576, v7
    v_and_b32 v13, 31, v1
    v_lshrrev_b32 v14, 5, v1
    s_lshr_b32 s35, s14, 1
    s_and_b32 s36, s14, 1
    s_lshl_b32 s37, s35, 12
    v_lshlrev_b32 v15, 7, v13
    v_add_u32 v15, s37, v15
    v_and_b32 v16, 7, v13

    v_xor_b32 v17, 0, v14
    v_xor_b32 v17, v17, v16
    v_lshl_add_u32 v20, v17, 4, v15
    v_xor_b32 v17, 2, v14
    v_xor_b32 v17, v17, v16
    v_lshl_add_u32 v21, v17, 4, v15
    v_xor_b32 v17, 4, v14
    v_xor_b32 v17, v17, v16
    v_lshl_add_u32 v22, v17, 4, v15
    v_xor_b32 v17, 6, v14
    v_xor_b32 v17, v17, v16
    v_lshl_add_u32 v23, v17, 4, v15
    v_and_b32 v17, 15, v1
    v_lshrrev_b32 v18, 2, v17
    v_and_b32 v17, 3, v17
    v_lshrrev_b32 v19, 4, v1
    v_lshrrev_b32 v24, 1, v19
    v_and_b32 v19, 1, v19
    v_lshl_add_u32 v24, v24, 3, v18
    v_lshlrev_b32 v25, 1, v19
    v_lshrrev_b32 v26, 1, v17
    v_add_u32 v25, v25, v26
    s_lshl_b32 s38, s36, 2
    v_add_u32 v25, s38, v25
    v_lshrrev_b32 v26, 1, v18
    v_lshlrev_b32 v26, 2, v26
    v_xor_b32 v25, v25, v26
    v_lshlrev_b32 v25, 4, v25
    v_and_b32 v26, 1, v17
    v_lshl_add_u32 v25, v26, 3, v25
    v_lshl_add_u32 v24, v24, 7, v25

    v_accvgpr_write_b32 a0, 0
    v_accvgpr_write_b32 a1, 0
    v_accvgpr_write_b32 a2, 0
    v_accvgpr_write_b32 a3, 0
    v_accvgpr_write_b32 a4, 0
    v_accvgpr_write_b32 a5, 0
    v_accvgpr_write_b32 a6, 0
    v_accvgpr_write_b32 a7, 0
    v_accvgpr_write_b32 a8, 0
    v_accvgpr_write_b32 a9, 0
    v_accvgpr_write_b32 a10, 0
    v_accvgpr_write_b32 a11, 0
    v_accvgpr_write_b32 a12, 0
    v_accvgpr_write_b32 a13, 0
    v_accvgpr_write_b32 a14, 0
    v_accvgpr_write_b32 a15, 0
    s_mov_b32 s40, 0
    s_mov_b32 s41, 0
    s_mul_i32 s42, s14, 2048
    s_add_u32 m0, s42, 0
    s_nop 0
    buffer_load_dwordx4 v6, s[20:23], s40 offen offset:0 lds
    s_mul_i32 s42, s14, 2048
    s_add_u32 m0, s42, 1024
    s_nop 0
    buffer_load_dwordx4 v9, s[20:23], s40 offen offset:0 lds
    s_mul_i32 s42, s14, 2048
    s_add_u32 m0, s42, 8064
    s_nop 0
    buffer_load_dwordx4 v6, s[20:23], s40 offen offset:128 lds
    s_mul_i32 s42, s14, 2048
    s_add_u32 m0, s42, 9088
    s_nop 0
    buffer_load_dwordx4 v9, s[20:23], s40 offen offset:128 lds
    s_mul_i32 s42, s14, 4096
    s_add_u32 m0, s42, 16384
    s_nop 0
    buffer_load_dwordx4 v7, s[24:27], s41 offen offset:0 lds
    s_mul_i32 s42, s14, 4096
    s_add_u32 m0, s42, 17408
    s_nop 0
    buffer_load_dwordx4 v10, s[24:27], s41 offen offset:0 lds
    s_mul_i32 s42, s14, 4096
    s_add_u32 m0, s42, 18432
    s_nop 0
    buffer_load_dwordx4 v11, s[24:27], s41 offen offset:0 lds
    s_mul_i32 s42, s14, 4096
    s_add_u32 m0, s42, 19456
    s_nop 0
    buffer_load_dwordx4 v12, s[24:27], s41 offen offset:0 lds
    s_add_u32 s40, s40, 256
    s_add_u32 s41, s41, 131072
    s_mul_i32 s42, s14, 2048
    s_add_u32 m0, s42, 32768
    s_nop 0
    buffer_load_dwordx4 v6, s[20:23], s40 offen offset:0 lds
    s_mul_i32 s42, s14, 2048
    s_add_u32 m0, s42, 33792
    s_nop 0
    buffer_load_dwordx4 v9, s[20:23], s40 offen offset:0 lds
    s_mul_i32 s42, s14, 2048
    s_add_u32 m0, s42, 40832
    s_nop 0
    buffer_load_dwordx4 v6, s[20:23], s40 offen offset:128 lds
    s_mul_i32 s42, s14, 2048
    s_add_u32 m0, s42, 41856
    s_nop 0
    buffer_load_dwordx4 v9, s[20:23], s40 offen offset:128 lds
    s_mul_i32 s42, s14, 4096
    s_add_u32 m0, s42, 49152
    s_nop 0
    buffer_load_dwordx4 v7, s[24:27], s41 offen offset:0 lds
    s_mul_i32 s42, s14, 4096
    s_add_u32 m0, s42, 50176
    s_nop 0
    buffer_load_dwordx4 v10, s[24:27], s41 offen offset:0 lds
    s_mul_i32 s42, s14, 4096
    s_add_u32 m0, s42, 51200
    s_nop 0
    buffer_load_dwordx4 v11, s[24:27], s41 offen offset:0 lds
    s_mul_i32 s42, s14, 4096
    s_add_u32 m0, s42, 52224
    s_nop 0
    buffer_load_dwordx4 v12, s[24:27], s41 offen offset:0 lds
    s_add_u32 s40, s40, 256
    s_add_u32 s41, s41, 131072
    s_waitcnt vmcnt(8)
    s_barrier
    ds_read_b128 v[32:35], v20 offset:0
    ds_read_b64_tr_b16 v[40:41], v24 offset:16384
    ds_read_b64_tr_b16 v[42:43], v24 offset:16896
    s_waitcnt lgkmcnt(0)
    v_mfma_f32_32x32x16_bf16 a[0:15], v[40:43], v[32:35], a[0:15]
    ds_read_b128 v[32:35], v21 offset:0
    ds_read_b64_tr_b16 v[40:41], v24 offset:18432
    ds_read_b64_tr_b16 v[42:43], v24 offset:18944
    s_waitcnt lgkmcnt(0)
    v_mfma_f32_32x32x16_bf16 a[0:15], v[40:43], v[32:35], a[0:15]
    ds_read_b128 v[32:35], v22 offset:0
    ds_read_b64_tr_b16 v[40:41], v24 offset:20480
    ds_read_b64_tr_b16 v[42:43], v24 offset:20992
    s_waitcnt lgkmcnt(0)
    v_mfma_f32_32x32x16_bf16 a[0:15], v[40:43], v[32:35], a[0:15]
    ds_read_b128 v[32:35], v23 offset:0
    ds_read_b64_tr_b16 v[40:41], v24 offset:22528
    ds_read_b64_tr_b16 v[42:43], v24 offset:23040
    s_waitcnt lgkmcnt(0)
    v_mfma_f32_32x32x16_bf16 a[0:15], v[40:43], v[32:35], a[0:15]
    ds_read_b128 v[32:35], v20 offset:8192
    ds_read_b64_tr_b16 v[40:41], v24 offset:24576
    ds_read_b64_tr_b16 v[42:43], v24 offset:25088
    s_waitcnt lgkmcnt(0)
    v_mfma_f32_32x32x16_bf16 a[0:15], v[40:43], v[32:35], a[0:15]
    ds_read_b128 v[32:35], v21 offset:8192
    ds_read_b64_tr_b16 v[40:41], v24 offset:26624
    ds_read_b64_tr_b16 v[42:43], v24 offset:27136
    s_waitcnt lgkmcnt(0)
    v_mfma_f32_32x32x16_bf16 a[0:15], v[40:43], v[32:35], a[0:15]
    ds_read_b128 v[32:35], v22 offset:8192
    ds_read_b64_tr_b16 v[40:41], v24 offset:28672
    ds_read_b64_tr_b16 v[42:43], v24 offset:29184
    s_waitcnt lgkmcnt(0)
    v_mfma_f32_32x32x16_bf16 a[0:15], v[40:43], v[32:35], a[0:15]
    ds_read_b128 v[32:35], v23 offset:8192
    ds_read_b64_tr_b16 v[40:41], v24 offset:30720
    ds_read_b64_tr_b16 v[42:43], v24 offset:31232
    s_waitcnt lgkmcnt(0)
    v_mfma_f32_32x32x16_bf16 a[0:15], v[40:43], v[32:35], a[0:15]
    s_barrier
    s_mul_i32 s42, s14, 2048
    s_add_u32 m0, s42, 0
    s_nop 0
    buffer_load_dwordx4 v6, s[20:23], s40 offen offset:0 lds
    s_mul_i32 s42, s14, 2048
    s_add_u32 m0, s42, 1024
    s_nop 0
    buffer_load_dwordx4 v9, s[20:23], s40 offen offset:0 lds
    s_mul_i32 s42, s14, 2048
    s_add_u32 m0, s42, 8064
    s_nop 0
    buffer_load_dwordx4 v6, s[20:23], s40 offen offset:128 lds
    s_mul_i32 s42, s14, 2048
    s_add_u32 m0, s42, 9088
    s_nop 0
    buffer_load_dwordx4 v9, s[20:23], s40 offen offset:128 lds
    s_mul_i32 s42, s14, 4096
    s_add_u32 m0, s42, 16384
    s_nop 0
    buffer_load_dwordx4 v7, s[24:27], s41 offen offset:0 lds
    s_mul_i32 s42, s14, 4096
    s_add_u32 m0, s42, 17408
    s_nop 0
    buffer_load_dwordx4 v10, s[24:27], s41 offen offset:0 lds
    s_mul_i32 s42, s14, 4096
    s_add_u32 m0, s42, 18432
    s_nop 0
    buffer_load_dwordx4 v11, s[24:27], s41 offen offset:0 lds
    s_mul_i32 s42, s14, 4096
    s_add_u32 m0, s42, 19456
    s_nop 0
    buffer_load_dwordx4 v12, s[24:27], s41 offen offset:0 lds
    s_add_u32 s40, s40, 256
    s_add_u32 s41, s41, 131072
    s_waitcnt vmcnt(8)
    s_barrier
    ds_read_b128 v[32:35], v20 offset:32768
    ds_read_b64_tr_b16 v[40:41], v24 offset:49152
    ds_read_b64_tr_b16 v[42:43], v24 offset:49664
    s_waitcnt lgkmcnt(0)
    v_mfma_f32_32x32x16_bf16 a[0:15], v[40:43], v[32:35], a[0:15]
    ds_read_b128 v[32:35], v21 offset:32768
    ds_read_b64_tr_b16 v[40:41], v24 offset:51200
    ds_read_b64_tr_b16 v[42:43], v24 offset:51712
    s_waitcnt lgkmcnt(0)
    v_mfma_f32_32x32x16_bf16 a[0:15], v[40:43], v[32:35], a[0:15]
    ds_read_b128 v[32:35], v22 offset:32768
    ds_read_b64_tr_b16 v[40:41], v24 offset:53248
    ds_read_b64_tr_b16 v[42:43], v24 offset:53760
    s_waitcnt lgkmcnt(0)
    v_mfma_f32_32x32x16_bf16 a[0:15], v[40:43], v[32:35], a[0:15]
    ds_read_b128 v[32:35], v23 offset:32768
    ds_read_b64_tr_b16 v[40:41], v24 offset:55296
    ds_read_b64_tr_b16 v[42:43], v24 offset:55808
    s_waitcnt lgkmcnt(0)
    v_mfma_f32_32x32x16_bf16 a[0:15], v[40:43], v[32:35], a[0:15]
    ds_read_b128 v[32:35], v20 offset:40960
    ds_read_b64_tr_b16 v[40:41], v24 offset:57344
    ds_read_b64_tr_b16 v[42:43], v24 offset:57856
    s_waitcnt lgkmcnt(0)
    v_mfma_f32_32x32x16_bf16 a[0:15], v[40:43], v[32:35], a[0:15]
    ds_read_b128 v[32:35], v21 offset:40960
    ds_read_b64_tr_b16 v[40:41], v24 offset:59392
    ds_read_b64_tr_b16 v[42:43], v24 offset:59904
    s_waitcnt lgkmcnt(0)
    v_mfma_f32_32x32x16_bf16 a[0:15], v[40:43], v[32:35], a[0:15]
    ds_read_b128 v[32:35], v22 offset:40960
    ds_read_b64_tr_b16 v[40:41], v24 offset:61440
    ds_read_b64_tr_b16 v[42:43], v24 offset:61952
    s_waitcnt lgkmcnt(0)
    v_mfma_f32_32x32x16_bf16 a[0:15], v[40:43], v[32:35], a[0:15]
    ds_read_b128 v[32:35], v23 offset:40960
    ds_read_b64_tr_b16 v[40:41], v24 offset:63488
    ds_read_b64_tr_b16 v[42:43], v24 offset:64000
    s_waitcnt lgkmcnt(0)
    v_mfma_f32_32x32x16_bf16 a[0:15], v[40:43], v[32:35], a[0:15]
    s_barrier
    s_mul_i32 s42, s14, 2048
    s_add_u32 m0, s42, 32768
    s_nop 0
    buffer_load_dwordx4 v6, s[20:23], s40 offen offset:0 lds
    s_mul_i32 s42, s14, 2048
    s_add_u32 m0, s42, 33792
    s_nop 0
    buffer_load_dwordx4 v9, s[20:23], s40 offen offset:0 lds
    s_mul_i32 s42, s14, 2048
    s_add_u32 m0, s42, 40832
    s_nop 0
    buffer_load_dwordx4 v6, s[20:23], s40 offen offset:128 lds
    s_mul_i32 s42, s14, 2048
    s_add_u32 m0, s42, 41856
    s_nop 0
    buffer_load_dwordx4 v9, s[20:23], s40 offen offset:128 lds
    s_mul_i32 s42, s14, 4096
    s_add_u32 m0, s42, 49152
    s_nop 0
    buffer_load_dwordx4 v7, s[24:27], s41 offen offset:0 lds
    s_mul_i32 s42, s14, 4096
    s_add_u32 m0, s42, 50176
    s_nop 0
    buffer_load_dwordx4 v10, s[24:27], s41 offen offset:0 lds
    s_mul_i32 s42, s14, 4096
    s_add_u32 m0, s42, 51200
    s_nop 0
    buffer_load_dwordx4 v11, s[24:27], s41 offen offset:0 lds
    s_mul_i32 s42, s14, 4096
    s_add_u32 m0, s42, 52224
    s_nop 0
    buffer_load_dwordx4 v12, s[24:27], s41 offen offset:0 lds
    s_add_u32 s40, s40, 256
    s_add_u32 s41, s41, 131072
    s_waitcnt vmcnt(8)
    s_barrier
    ds_read_b128 v[32:35], v20 offset:0
    ds_read_b64_tr_b16 v[40:41], v24 offset:16384
    ds_read_b64_tr_b16 v[42:43], v24 offset:16896
    s_waitcnt lgkmcnt(0)
    v_mfma_f32_32x32x16_bf16 a[0:15], v[40:43], v[32:35], a[0:15]
    ds_read_b128 v[32:35], v21 offset:0
    ds_read_b64_tr_b16 v[40:41], v24 offset:18432
    ds_read_b64_tr_b16 v[42:43], v24 offset:18944
    s_waitcnt lgkmcnt(0)
    v_mfma_f32_32x32x16_bf16 a[0:15], v[40:43], v[32:35], a[0:15]
    ds_read_b128 v[32:35], v22 offset:0
    ds_read_b64_tr_b16 v[40:41], v24 offset:20480
    ds_read_b64_tr_b16 v[42:43], v24 offset:20992
    s_waitcnt lgkmcnt(0)
    v_mfma_f32_32x32x16_bf16 a[0:15], v[40:43], v[32:35], a[0:15]
    ds_read_b128 v[32:35], v23 offset:0
    ds_read_b64_tr_b16 v[40:41], v24 offset:22528
    ds_read_b64_tr_b16 v[42:43], v24 offset:23040
    s_waitcnt lgkmcnt(0)
    v_mfma_f32_32x32x16_bf16 a[0:15], v[40:43], v[32:35], a[0:15]
    ds_read_b128 v[32:35], v20 offset:8192
    ds_read_b64_tr_b16 v[40:41], v24 offset:24576
    ds_read_b64_tr_b16 v[42:43], v24 offset:25088
    s_waitcnt lgkmcnt(0)
    v_mfma_f32_32x32x16_bf16 a[0:15], v[40:43], v[32:35], a[0:15]
    ds_read_b128 v[32:35], v21 offset:8192
    ds_read_b64_tr_b16 v[40:41], v24 offset:26624
    ds_read_b64_tr_b16 v[42:43], v24 offset:27136
    s_waitcnt lgkmcnt(0)
    v_mfma_f32_32x32x16_bf16 a[0:15], v[40:43], v[32:35], a[0:15]
    ds_read_b128 v[32:35], v22 offset:8192
    ds_read_b64_tr_b16 v[40:41], v24 offset:28672
    ds_read_b64_tr_b16 v[42:43], v24 offset:29184
    s_waitcnt lgkmcnt(0)
    v_mfma_f32_32x32x16_bf16 a[0:15], v[40:43], v[32:35], a[0:15]
    ds_read_b128 v[32:35], v23 offset:8192
    ds_read_b64_tr_b16 v[40:41], v24 offset:30720
    ds_read_b64_tr_b16 v[42:43], v24 offset:31232
    s_waitcnt lgkmcnt(0)
    v_mfma_f32_32x32x16_bf16 a[0:15], v[40:43], v[32:35], a[0:15]
    s_barrier
    s_mul_i32 s42, s14, 2048
    s_add_u32 m0, s42, 0
    s_nop 0
    buffer_load_dwordx4 v6, s[20:23], s40 offen offset:0 lds
    s_mul_i32 s42, s14, 2048
    s_add_u32 m0, s42, 1024
    s_nop 0
    buffer_load_dwordx4 v9, s[20:23], s40 offen offset:0 lds
    s_mul_i32 s42, s14, 2048
    s_add_u32 m0, s42, 8064
    s_nop 0
    buffer_load_dwordx4 v6, s[20:23], s40 offen offset:128 lds
    s_mul_i32 s42, s14, 2048
    s_add_u32 m0, s42, 9088
    s_nop 0
    buffer_load_dwordx4 v9, s[20:23], s40 offen offset:128 lds
    s_mul_i32 s42, s14, 4096
    s_add_u32 m0, s42, 16384
    s_nop 0
    buffer_load_dwordx4 v7, s[24:27], s41 offen offset:0 lds
    s_mul_i32 s42, s14, 4096
    s_add_u32 m0, s42, 17408
    s_nop 0
    buffer_load_dwordx4 v10, s[24:27], s41 offen offset:0 lds
    s_mul_i32 s42, s14, 4096
    s_add_u32 m0, s42, 18432
    s_nop 0
    buffer_load_dwordx4 v11, s[24:27], s41 offen offset:0 lds
    s_mul_i32 s42, s14, 4096
    s_add_u32 m0, s42, 19456
    s_nop 0
    buffer_load_dwordx4 v12, s[24:27], s41 offen offset:0 lds
    s_add_u32 s40, s40, 256
    s_add_u32 s41, s41, 131072
    s_waitcnt vmcnt(8)
    s_barrier
    ds_read_b128 v[32:35], v20 offset:32768
    ds_read_b64_tr_b16 v[40:41], v24 offset:49152
    ds_read_b64_tr_b16 v[42:43], v24 offset:49664
    s_waitcnt lgkmcnt(0)
    v_mfma_f32_32x32x16_bf16 a[0:15], v[40:43], v[32:35], a[0:15]
    ds_read_b128 v[32:35], v21 offset:32768
    ds_read_b64_tr_b16 v[40:41], v24 offset:51200
    ds_read_b64_tr_b16 v[42:43], v24 offset:51712
    s_waitcnt lgkmcnt(0)
    v_mfma_f32_32x32x16_bf16 a[0:15], v[40:43], v[32:35], a[0:15]
    ds_read_b128 v[32:35], v22 offset:32768
    ds_read_b64_tr_b16 v[40:41], v24 offset:53248
    ds_read_b64_tr_b16 v[42:43], v24 offset:53760
    s_waitcnt lgkmcnt(0)
    v_mfma_f32_32x32x16_bf16 a[0:15], v[40:43], v[32:35], a[0:15]
    ds_read_b128 v[32:35], v23 offset:32768
    ds_read_b64_tr_b16 v[40:41], v24 offset:55296
    ds_read_b64_tr_b16 v[42:43], v24 offset:55808
    s_waitcnt lgkmcnt(0)
    v_mfma_f32_32x32x16_bf16 a[0:15], v[40:43], v[32:35], a[0:15]
    ds_read_b128 v[32:35], v20 offset:40960
    ds_read_b64_tr_b16 v[40:41], v24 offset:57344
    ds_read_b64_tr_b16 v[42:43], v24 offset:57856
    s_waitcnt lgkmcnt(0)
    v_mfma_f32_32x32x16_bf16 a[0:15], v[40:43], v[32:35], a[0:15]
    ds_read_b128 v[32:35], v21 offset:40960
    ds_read_b64_tr_b16 v[40:41], v24 offset:59392
    ds_read_b64_tr_b16 v[42:43], v24 offset:59904
    s_waitcnt lgkmcnt(0)
    v_mfma_f32_32x32x16_bf16 a[0:15], v[40:43], v[32:35], a[0:15]
    ds_read_b128 v[32:35], v22 offset:40960
    ds_read_b64_tr_b16 v[40:41], v24 offset:61440
    ds_read_b64_tr_b16 v[42:43], v24 offset:61952
    s_waitcnt lgkmcnt(0)
    v_mfma_f32_32x32x16_bf16 a[0:15], v[40:43], v[32:35], a[0:15]
    ds_read_b128 v[32:35], v23 offset:40960
    ds_read_b64_tr_b16 v[40:41], v24 offset:63488
    ds_read_b64_tr_b16 v[42:43], v24 offset:64000
    s_waitcnt lgkmcnt(0)
    v_mfma_f32_32x32x16_bf16 a[0:15], v[40:43], v[32:35], a[0:15]
    s_barrier
    s_mul_i32 s42, s14, 2048
    s_add_u32 m0, s42, 32768
    s_nop 0
    buffer_load_dwordx4 v6, s[20:23], s40 offen offset:0 lds
    s_mul_i32 s42, s14, 2048
    s_add_u32 m0, s42, 33792
    s_nop 0
    buffer_load_dwordx4 v9, s[20:23], s40 offen offset:0 lds
    s_mul_i32 s42, s14, 2048
    s_add_u32 m0, s42, 40832
    s_nop 0
    buffer_load_dwordx4 v6, s[20:23], s40 offen offset:128 lds
    s_mul_i32 s42, s14, 2048
    s_add_u32 m0, s42, 41856
    s_nop 0
    buffer_load_dwordx4 v9, s[20:23], s40 offen offset:128 lds
    s_mul_i32 s42, s14, 4096
    s_add_u32 m0, s42, 49152
    s_nop 0
    buffer_load_dwordx4 v7, s[24:27], s41 offen offset:0 lds
    s_mul_i32 s42, s14, 4096
    s_add_u32 m0, s42, 50176
    s_nop 0
    buffer_load_dwordx4 v10, s[24:27], s41 offen offset:0 lds
    s_mul_i32 s42, s14, 4096
    s_add_u32 m0, s42, 51200
    s_nop 0
    buffer_load_dwordx4 v11, s[24:27], s41 offen offset:0 lds
    s_mul_i32 s42, s14, 4096
    s_add_u32 m0, s42, 52224
    s_nop 0
    buffer_load_dwordx4 v12, s[24:27], s41 offen offset:0 lds
    s_add_u32 s40, s40, 256
    s_add_u32 s41, s41, 131072
    s_waitcnt vmcnt(8)
    s_barrier
    ds_read_b128 v[32:35], v20 offset:0
    ds_read_b64_tr_b16 v[40:41], v24 offset:16384
    ds_read_b64_tr_b16 v[42:43], v24 offset:16896
    s_waitcnt lgkmcnt(0)
    v_mfma_f32_32x32x16_bf16 a[0:15], v[40:43], v[32:35], a[0:15]
    ds_read_b128 v[32:35], v21 offset:0
    ds_read_b64_tr_b16 v[40:41], v24 offset:18432
    ds_read_b64_tr_b16 v[42:43], v24 offset:18944
    s_waitcnt lgkmcnt(0)
    v_mfma_f32_32x32x16_bf16 a[0:15], v[40:43], v[32:35], a[0:15]
    ds_read_b128 v[32:35], v22 offset:0
    ds_read_b64_tr_b16 v[40:41], v24 offset:20480
    ds_read_b64_tr_b16 v[42:43], v24 offset:20992
    s_waitcnt lgkmcnt(0)
    v_mfma_f32_32x32x16_bf16 a[0:15], v[40:43], v[32:35], a[0:15]
    ds_read_b128 v[32:35], v23 offset:0
    ds_read_b64_tr_b16 v[40:41], v24 offset:22528
    ds_read_b64_tr_b16 v[42:43], v24 offset:23040
    s_waitcnt lgkmcnt(0)
    v_mfma_f32_32x32x16_bf16 a[0:15], v[40:43], v[32:35], a[0:15]
    ds_read_b128 v[32:35], v20 offset:8192
    ds_read_b64_tr_b16 v[40:41], v24 offset:24576
    ds_read_b64_tr_b16 v[42:43], v24 offset:25088
    s_waitcnt lgkmcnt(0)
    v_mfma_f32_32x32x16_bf16 a[0:15], v[40:43], v[32:35], a[0:15]
    ds_read_b128 v[32:35], v21 offset:8192
    ds_read_b64_tr_b16 v[40:41], v24 offset:26624
    ds_read_b64_tr_b16 v[42:43], v24 offset:27136
    s_waitcnt lgkmcnt(0)
    v_mfma_f32_32x32x16_bf16 a[0:15], v[40:43], v[32:35], a[0:15]
    ds_read_b128 v[32:35], v22 offset:8192
    ds_read_b64_tr_b16 v[40:41], v24 offset:28672
    ds_read_b64_tr_b16 v[42:43], v24 offset:29184
    s_waitcnt lgkmcnt(0)
    v_mfma_f32_32x32x16_bf16 a[0:15], v[40:43], v[32:35], a[0:15]
    ds_read_b128 v[32:35], v23 offset:8192
    ds_read_b64_tr_b16 v[40:41], v24 offset:30720
    ds_read_b64_tr_b16 v[42:43], v24 offset:31232
    s_waitcnt lgkmcnt(0)
    v_mfma_f32_32x32x16_bf16 a[0:15], v[40:43], v[32:35], a[0:15]
    s_barrier
    s_mul_i32 s42, s14, 2048
    s_add_u32 m0, s42, 0
    s_nop 0
    buffer_load_dwordx4 v6, s[20:23], s40 offen offset:0 lds
    s_mul_i32 s42, s14, 2048
    s_add_u32 m0, s42, 1024
    s_nop 0
    buffer_load_dwordx4 v9, s[20:23], s40 offen offset:0 lds
    s_mul_i32 s42, s14, 2048
    s_add_u32 m0, s42, 8064
    s_nop 0
    buffer_load_dwordx4 v6, s[20:23], s40 offen offset:128 lds
    s_mul_i32 s42, s14, 2048
    s_add_u32 m0, s42, 9088
    s_nop 0
    buffer_load_dwordx4 v9, s[20:23], s40 offen offset:128 lds
    s_mul_i32 s42, s14, 4096
    s_add_u32 m0, s42, 16384
    s_nop 0
    buffer_load_dwordx4 v7, s[24:27], s41 offen offset:0 lds
    s_mul_i32 s42, s14, 4096
    s_add_u32 m0, s42, 17408
    s_nop 0
    buffer_load_dwordx4 v10, s[24:27], s41 offen offset:0 lds
    s_mul_i32 s42, s14, 4096
    s_add_u32 m0, s42, 18432
    s_nop 0
    buffer_load_dwordx4 v11, s[24:27], s41 offen offset:0 lds
    s_mul_i32 s42, s14, 4096
    s_add_u32 m0, s42, 19456
    s_nop 0
    buffer_load_dwordx4 v12, s[24:27], s41 offen offset:0 lds
    s_add_u32 s40, s40, 256
    s_add_u32 s41, s41, 131072
    s_waitcnt vmcnt(8)
    s_barrier
    ds_read_b128 v[32:35], v20 offset:32768
    ds_read_b64_tr_b16 v[40:41], v24 offset:49152
    ds_read_b64_tr_b16 v[42:43], v24 offset:49664
    s_waitcnt lgkmcnt(0)
    v_mfma_f32_32x32x16_bf16 a[0:15], v[40:43], v[32:35], a[0:15]
    ds_read_b128 v[32:35], v21 offset:32768
    ds_read_b64_tr_b16 v[40:41], v24 offset:51200
    ds_read_b64_tr_b16 v[42:43], v24 offset:51712
    s_waitcnt lgkmcnt(0)
    v_mfma_f32_32x32x16_bf16 a[0:15], v[40:43], v[32:35], a[0:15]
    ds_read_b128 v[32:35], v22 offset:32768
    ds_read_b64_tr_b16 v[40:41], v24 offset:53248
    ds_read_b64_tr_b16 v[42:43], v24 offset:53760
    s_waitcnt lgkmcnt(0)
    v_mfma_f32_32x32x16_bf16 a[0:15], v[40:43], v[32:35], a[0:15]
    ds_read_b128 v[32:35], v23 offset:32768
    ds_read_b64_tr_b16 v[40:41], v24 offset:55296
    ds_read_b64_tr_b16 v[42:43], v24 offset:55808
    s_waitcnt lgkmcnt(0)
    v_mfma_f32_32x32x16_bf16 a[0:15], v[40:43], v[32:35], a[0:15]
    ds_read_b128 v[32:35], v20 offset:40960
    ds_read_b64_tr_b16 v[40:41], v24 offset:57344
    ds_read_b64_tr_b16 v[42:43], v24 offset:57856
    s_waitcnt lgkmcnt(0)
    v_mfma_f32_32x32x16_bf16 a[0:15], v[40:43], v[32:35], a[0:15]
    ds_read_b128 v[32:35], v21 offset:40960
    ds_read_b64_tr_b16 v[40:41], v24 offset:59392
    ds_read_b64_tr_b16 v[42:43], v24 offset:59904
    s_waitcnt lgkmcnt(0)
    v_mfma_f32_32x32x16_bf16 a[0:15], v[40:43], v[32:35], a[0:15]
    ds_read_b128 v[32:35], v22 offset:40960
    ds_read_b64_tr_b16 v[40:41], v24 offset:61440
    ds_read_b64_tr_b16 v[42:43], v24 offset:61952
    s_waitcnt lgkmcnt(0)
    v_mfma_f32_32x32x16_bf16 a[0:15], v[40:43], v[32:35], a[0:15]
    ds_read_b128 v[32:35], v23 offset:40960
    ds_read_b64_tr_b16 v[40:41], v24 offset:63488
    ds_read_b64_tr_b16 v[42:43], v24 offset:64000
    s_waitcnt lgkmcnt(0)
    v_mfma_f32_32x32x16_bf16 a[0:15], v[40:43], v[32:35], a[0:15]
    s_barrier
    s_mul_i32 s42, s14, 2048
    s_add_u32 m0, s42, 32768
    s_nop 0
    buffer_load_dwordx4 v6, s[20:23], s40 offen offset:0 lds
    s_mul_i32 s42, s14, 2048
    s_add_u32 m0, s42, 33792
    s_nop 0
    buffer_load_dwordx4 v9, s[20:23], s40 offen offset:0 lds
    s_mul_i32 s42, s14, 2048
    s_add_u32 m0, s42, 40832
    s_nop 0
    buffer_load_dwordx4 v6, s[20:23], s40 offen offset:128 lds
    s_mul_i32 s42, s14, 2048
    s_add_u32 m0, s42, 41856
    s_nop 0
    buffer_load_dwordx4 v9, s[20:23], s40 offen offset:128 lds
    s_mul_i32 s42, s14, 4096
    s_add_u32 m0, s42, 49152
    s_nop 0
    buffer_load_dwordx4 v7, s[24:27], s41 offen offset:0 lds
    s_mul_i32 s42, s14, 4096
    s_add_u32 m0, s42, 50176
    s_nop 0
    buffer_load_dwordx4 v10, s[24:27], s41 offen offset:0 lds
    s_mul_i32 s42, s14, 4096
    s_add_u32 m0, s42, 51200
    s_nop 0
    buffer_load_dwordx4 v11, s[24:27], s41 offen offset:0 lds
    s_mul_i32 s42, s14, 4096
    s_add_u32 m0, s42, 52224
    s_nop 0
    buffer_load_dwordx4 v12, s[24:27], s41 offen offset:0 lds
    s_add_u32 s40, s40, 256
    s_add_u32 s41, s41, 131072
    s_waitcnt vmcnt(8)
    s_barrier
    ds_read_b128 v[32:35], v20 offset:0
    ds_read_b64_tr_b16 v[40:41], v24 offset:16384
    ds_read_b64_tr_b16 v[42:43], v24 offset:16896
    s_waitcnt lgkmcnt(0)
    v_mfma_f32_32x32x16_bf16 a[0:15], v[40:43], v[32:35], a[0:15]
    ds_read_b128 v[32:35], v21 offset:0
    ds_read_b64_tr_b16 v[40:41], v24 offset:18432
    ds_read_b64_tr_b16 v[42:43], v24 offset:18944
    s_waitcnt lgkmcnt(0)
    v_mfma_f32_32x32x16_bf16 a[0:15], v[40:43], v[32:35], a[0:15]
    ds_read_b128 v[32:35], v22 offset:0
    ds_read_b64_tr_b16 v[40:41], v24 offset:20480
    ds_read_b64_tr_b16 v[42:43], v24 offset:20992
    s_waitcnt lgkmcnt(0)
    v_mfma_f32_32x32x16_bf16 a[0:15], v[40:43], v[32:35], a[0:15]
    ds_read_b128 v[32:35], v23 offset:0
    ds_read_b64_tr_b16 v[40:41], v24 offset:22528
    ds_read_b64_tr_b16 v[42:43], v24 offset:23040
    s_waitcnt lgkmcnt(0)
    v_mfma_f32_32x32x16_bf16 a[0:15], v[40:43], v[32:35], a[0:15]
    ds_read_b128 v[32:35], v20 offset:8192
    ds_read_b64_tr_b16 v[40:41], v24 offset:24576
    ds_read_b64_tr_b16 v[42:43], v24 offset:25088
    s_waitcnt lgkmcnt(0)
    v_mfma_f32_32x32x16_bf16 a[0:15], v[40:43], v[32:35], a[0:15]
    ds_read_b128 v[32:35], v21 offset:8192
    ds_read_b64_tr_b16 v[40:41], v24 offset:26624
    ds_read_b64_tr_b16 v[42:43], v24 offset:27136
    s_waitcnt lgkmcnt(0)
    v_mfma_f32_32x32x16_bf16 a[0:15], v[40:43], v[32:35], a[0:15]
    ds_read_b128 v[32:35], v22 offset:8192
    ds_read_b64_tr_b16 v[40:41], v24 offset:28672
    ds_read_b64_tr_b16 v[42:43], v24 offset:29184
    s_waitcnt lgkmcnt(0)
    v_mfma_f32_32x32x16_bf16 a[0:15], v[40:43], v[32:35], a[0:15]
    ds_read_b128 v[32:35], v23 offset:8192
    ds_read_b64_tr_b16 v[40:41], v24 offset:30720
    ds_read_b64_tr_b16 v[42:43], v24 offset:31232
    s_waitcnt lgkmcnt(0)
    v_mfma_f32_32x32x16_bf16 a[0:15], v[40:43], v[32:35], a[0:15]
    s_barrier
    s_mul_i32 s42, s14, 2048
    s_add_u32 m0, s42, 0
    s_nop 0
    buffer_load_dwordx4 v6, s[20:23], s40 offen offset:0 lds
    s_mul_i32 s42, s14, 2048
    s_add_u32 m0, s42, 1024
    s_nop 0
    buffer_load_dwordx4 v9, s[20:23], s40 offen offset:0 lds
    s_mul_i32 s42, s14, 2048
    s_add_u32 m0, s42, 8064
    s_nop 0
    buffer_load_dwordx4 v6, s[20:23], s40 offen offset:128 lds
    s_mul_i32 s42, s14, 2048
    s_add_u32 m0, s42, 9088
    s_nop 0
    buffer_load_dwordx4 v9, s[20:23], s40 offen offset:128 lds
    s_mul_i32 s42, s14, 4096
    s_add_u32 m0, s42, 16384
    s_nop 0
    buffer_load_dwordx4 v7, s[24:27], s41 offen offset:0 lds
    s_mul_i32 s42, s14, 4096
    s_add_u32 m0, s42, 17408
    s_nop 0
    buffer_load_dwordx4 v10, s[24:27], s41 offen offset:0 lds
    s_mul_i32 s42, s14, 4096
    s_add_u32 m0, s42, 18432
    s_nop 0
    buffer_load_dwordx4 v11, s[24:27], s41 offen offset:0 lds
    s_mul_i32 s42, s14, 4096
    s_add_u32 m0, s42, 19456
    s_nop 0
    buffer_load_dwordx4 v12, s[24:27], s41 offen offset:0 lds
    s_add_u32 s40, s40, 256
    s_add_u32 s41, s41, 131072
    s_waitcnt vmcnt(8)
    s_barrier
    ds_read_b128 v[32:35], v20 offset:32768
    ds_read_b64_tr_b16 v[40:41], v24 offset:49152
    ds_read_b64_tr_b16 v[42:43], v24 offset:49664
    s_waitcnt lgkmcnt(0)
    v_mfma_f32_32x32x16_bf16 a[0:15], v[40:43], v[32:35], a[0:15]
    ds_read_b128 v[32:35], v21 offset:32768
    ds_read_b64_tr_b16 v[40:41], v24 offset:51200
    ds_read_b64_tr_b16 v[42:43], v24 offset:51712
    s_waitcnt lgkmcnt(0)
    v_mfma_f32_32x32x16_bf16 a[0:15], v[40:43], v[32:35], a[0:15]
    ds_read_b128 v[32:35], v22 offset:32768
    ds_read_b64_tr_b16 v[40:41], v24 offset:53248
    ds_read_b64_tr_b16 v[42:43], v24 offset:53760
    s_waitcnt lgkmcnt(0)
    v_mfma_f32_32x32x16_bf16 a[0:15], v[40:43], v[32:35], a[0:15]
    ds_read_b128 v[32:35], v23 offset:32768
    ds_read_b64_tr_b16 v[40:41], v24 offset:55296
    ds_read_b64_tr_b16 v[42:43], v24 offset:55808
    s_waitcnt lgkmcnt(0)
    v_mfma_f32_32x32x16_bf16 a[0:15], v[40:43], v[32:35], a[0:15]
    ds_read_b128 v[32:35], v20 offset:40960
    ds_read_b64_tr_b16 v[40:41], v24 offset:57344
    ds_read_b64_tr_b16 v[42:43], v24 offset:57856
    s_waitcnt lgkmcnt(0)
    v_mfma_f32_32x32x16_bf16 a[0:15], v[40:43], v[32:35], a[0:15]
    ds_read_b128 v[32:35], v21 offset:40960
    ds_read_b64_tr_b16 v[40:41], v24 offset:59392
    ds_read_b64_tr_b16 v[42:43], v24 offset:59904
    s_waitcnt lgkmcnt(0)
    v_mfma_f32_32x32x16_bf16 a[0:15], v[40:43], v[32:35], a[0:15]
    ds_read_b128 v[32:35], v22 offset:40960
    ds_read_b64_tr_b16 v[40:41], v24 offset:61440
    ds_read_b64_tr_b16 v[42:43], v24 offset:61952
    s_waitcnt lgkmcnt(0)
    v_mfma_f32_32x32x16_bf16 a[0:15], v[40:43], v[32:35], a[0:15]
    ds_read_b128 v[32:35], v23 offset:40960
    ds_read_b64_tr_b16 v[40:41], v24 offset:63488
    ds_read_b64_tr_b16 v[42:43], v24 offset:64000
    s_waitcnt lgkmcnt(0)
    v_mfma_f32_32x32x16_bf16 a[0:15], v[40:43], v[32:35], a[0:15]
    s_barrier
    s_mul_i32 s42, s14, 2048
    s_add_u32 m0, s42, 32768
    s_nop 0
    buffer_load_dwordx4 v6, s[20:23], s40 offen offset:0 lds
    s_mul_i32 s42, s14, 2048
    s_add_u32 m0, s42, 33792
    s_nop 0
    buffer_load_dwordx4 v9, s[20:23], s40 offen offset:0 lds
    s_mul_i32 s42, s14, 2048
    s_add_u32 m0, s42, 40832
    s_nop 0
    buffer_load_dwordx4 v6, s[20:23], s40 offen offset:128 lds
    s_mul_i32 s42, s14, 2048
    s_add_u32 m0, s42, 41856
    s_nop 0
    buffer_load_dwordx4 v9, s[20:23], s40 offen offset:128 lds
    s_mul_i32 s42, s14, 4096
    s_add_u32 m0, s42, 49152
    s_nop 0
    buffer_load_dwordx4 v7, s[24:27], s41 offen offset:0 lds
    s_mul_i32 s42, s14, 4096
    s_add_u32 m0, s42, 50176
    s_nop 0
    buffer_load_dwordx4 v10, s[24:27], s41 offen offset:0 lds
    s_mul_i32 s42, s14, 4096
    s_add_u32 m0, s42, 51200
    s_nop 0
    buffer_load_dwordx4 v11, s[24:27], s41 offen offset:0 lds
    s_mul_i32 s42, s14, 4096
    s_add_u32 m0, s42, 52224
    s_nop 0
    buffer_load_dwordx4 v12, s[24:27], s41 offen offset:0 lds
    s_add_u32 s40, s40, 256
    s_add_u32 s41, s41, 131072
    s_waitcnt vmcnt(8)
    s_barrier
    ds_read_b128 v[32:35], v20 offset:0
    ds_read_b64_tr_b16 v[40:41], v24 offset:16384
    ds_read_b64_tr_b16 v[42:43], v24 offset:16896
    s_waitcnt lgkmcnt(0)
    v_mfma_f32_32x32x16_bf16 a[0:15], v[40:43], v[32:35], a[0:15]
    ds_read_b128 v[32:35], v21 offset:0
    ds_read_b64_tr_b16 v[40:41], v24 offset:18432
    ds_read_b64_tr_b16 v[42:43], v24 offset:18944
    s_waitcnt lgkmcnt(0)
    v_mfma_f32_32x32x16_bf16 a[0:15], v[40:43], v[32:35], a[0:15]
    ds_read_b128 v[32:35], v22 offset:0
    ds_read_b64_tr_b16 v[40:41], v24 offset:20480
    ds_read_b64_tr_b16 v[42:43], v24 offset:20992
    s_waitcnt lgkmcnt(0)
    v_mfma_f32_32x32x16_bf16 a[0:15], v[40:43], v[32:35], a[0:15]
    ds_read_b128 v[32:35], v23 offset:0
    ds_read_b64_tr_b16 v[40:41], v24 offset:22528
    ds_read_b64_tr_b16 v[42:43], v24 offset:23040
    s_waitcnt lgkmcnt(0)
    v_mfma_f32_32x32x16_bf16 a[0:15], v[40:43], v[32:35], a[0:15]
    ds_read_b128 v[32:35], v20 offset:8192
    ds_read_b64_tr_b16 v[40:41], v24 offset:24576
    ds_read_b64_tr_b16 v[42:43], v24 offset:25088
    s_waitcnt lgkmcnt(0)
    v_mfma_f32_32x32x16_bf16 a[0:15], v[40:43], v[32:35], a[0:15]
    ds_read_b128 v[32:35], v21 offset:8192
    ds_read_b64_tr_b16 v[40:41], v24 offset:26624
    ds_read_b64_tr_b16 v[42:43], v24 offset:27136
    s_waitcnt lgkmcnt(0)
    v_mfma_f32_32x32x16_bf16 a[0:15], v[40:43], v[32:35], a[0:15]
    ds_read_b128 v[32:35], v22 offset:8192
    ds_read_b64_tr_b16 v[40:41], v24 offset:28672
    ds_read_b64_tr_b16 v[42:43], v24 offset:29184
    s_waitcnt lgkmcnt(0)
    v_mfma_f32_32x32x16_bf16 a[0:15], v[40:43], v[32:35], a[0:15]
    ds_read_b128 v[32:35], v23 offset:8192
    ds_read_b64_tr_b16 v[40:41], v24 offset:30720
    ds_read_b64_tr_b16 v[42:43], v24 offset:31232
    s_waitcnt lgkmcnt(0)
    v_mfma_f32_32x32x16_bf16 a[0:15], v[40:43], v[32:35], a[0:15]
    s_barrier
    s_mul_i32 s42, s14, 2048
    s_add_u32 m0, s42, 0
    s_nop 0
    buffer_load_dwordx4 v6, s[20:23], s40 offen offset:0 lds
    s_mul_i32 s42, s14, 2048
    s_add_u32 m0, s42, 1024
    s_nop 0
    buffer_load_dwordx4 v9, s[20:23], s40 offen offset:0 lds
    s_mul_i32 s42, s14, 2048
    s_add_u32 m0, s42, 8064
    s_nop 0
    buffer_load_dwordx4 v6, s[20:23], s40 offen offset:128 lds
    s_mul_i32 s42, s14, 2048
    s_add_u32 m0, s42, 9088
    s_nop 0
    buffer_load_dwordx4 v9, s[20:23], s40 offen offset:128 lds
    s_mul_i32 s42, s14, 4096
    s_add_u32 m0, s42, 16384
    s_nop 0
    buffer_load_dwordx4 v7, s[24:27], s41 offen offset:0 lds
    s_mul_i32 s42, s14, 4096
    s_add_u32 m0, s42, 17408
    s_nop 0
    buffer_load_dwordx4 v10, s[24:27], s41 offen offset:0 lds
    s_mul_i32 s42, s14, 4096
    s_add_u32 m0, s42, 18432
    s_nop 0
    buffer_load_dwordx4 v11, s[24:27], s41 offen offset:0 lds
    s_mul_i32 s42, s14, 4096
    s_add_u32 m0, s42, 19456
    s_nop 0
    buffer_load_dwordx4 v12, s[24:27], s41 offen offset:0 lds
    s_add_u32 s40, s40, 256
    s_add_u32 s41, s41, 131072
    s_waitcnt vmcnt(8)
    s_barrier
    ds_read_b128 v[32:35], v20 offset:32768
    ds_read_b64_tr_b16 v[40:41], v24 offset:49152
    ds_read_b64_tr_b16 v[42:43], v24 offset:49664
    s_waitcnt lgkmcnt(0)
    v_mfma_f32_32x32x16_bf16 a[0:15], v[40:43], v[32:35], a[0:15]
    ds_read_b128 v[32:35], v21 offset:32768
    ds_read_b64_tr_b16 v[40:41], v24 offset:51200
    ds_read_b64_tr_b16 v[42:43], v24 offset:51712
    s_waitcnt lgkmcnt(0)
    v_mfma_f32_32x32x16_bf16 a[0:15], v[40:43], v[32:35], a[0:15]
    ds_read_b128 v[32:35], v22 offset:32768
    ds_read_b64_tr_b16 v[40:41], v24 offset:53248
    ds_read_b64_tr_b16 v[42:43], v24 offset:53760
    s_waitcnt lgkmcnt(0)
    v_mfma_f32_32x32x16_bf16 a[0:15], v[40:43], v[32:35], a[0:15]
    ds_read_b128 v[32:35], v23 offset:32768
    ds_read_b64_tr_b16 v[40:41], v24 offset:55296
    ds_read_b64_tr_b16 v[42:43], v24 offset:55808
    s_waitcnt lgkmcnt(0)
    v_mfma_f32_32x32x16_bf16 a[0:15], v[40:43], v[32:35], a[0:15]
    ds_read_b128 v[32:35], v20 offset:40960
    ds_read_b64_tr_b16 v[40:41], v24 offset:57344
    ds_read_b64_tr_b16 v[42:43], v24 offset:57856
    s_waitcnt lgkmcnt(0)
    v_mfma_f32_32x32x16_bf16 a[0:15], v[40:43], v[32:35], a[0:15]
    ds_read_b128 v[32:35], v21 offset:40960
    ds_read_b64_tr_b16 v[40:41], v24 offset:59392
    ds_read_b64_tr_b16 v[42:43], v24 offset:59904
    s_waitcnt lgkmcnt(0)
    v_mfma_f32_32x32x16_bf16 a[0:15], v[40:43], v[32:35], a[0:15]
    ds_read_b128 v[32:35], v22 offset:40960
    ds_read_b64_tr_b16 v[40:41], v24 offset:61440
    ds_read_b64_tr_b16 v[42:43], v24 offset:61952
    s_waitcnt lgkmcnt(0)
    v_mfma_f32_32x32x16_bf16 a[0:15], v[40:43], v[32:35], a[0:15]
    ds_read_b128 v[32:35], v23 offset:40960
    ds_read_b64_tr_b16 v[40:41], v24 offset:63488
    ds_read_b64_tr_b16 v[42:43], v24 offset:64000
    s_waitcnt lgkmcnt(0)
    v_mfma_f32_32x32x16_bf16 a[0:15], v[40:43], v[32:35], a[0:15]
    s_barrier
    s_mul_i32 s42, s14, 2048
    s_add_u32 m0, s42, 32768
    s_nop 0
    buffer_load_dwordx4 v6, s[20:23], s40 offen offset:0 lds
    s_mul_i32 s42, s14, 2048
    s_add_u32 m0, s42, 33792
    s_nop 0
    buffer_load_dwordx4 v9, s[20:23], s40 offen offset:0 lds
    s_mul_i32 s42, s14, 2048
    s_add_u32 m0, s42, 40832
    s_nop 0
    buffer_load_dwordx4 v6, s[20:23], s40 offen offset:128 lds
    s_mul_i32 s42, s14, 2048
    s_add_u32 m0, s42, 41856
    s_nop 0
    buffer_load_dwordx4 v9, s[20:23], s40 offen offset:128 lds
    s_mul_i32 s42, s14, 4096
    s_add_u32 m0, s42, 49152
    s_nop 0
    buffer_load_dwordx4 v7, s[24:27], s41 offen offset:0 lds
    s_mul_i32 s42, s14, 4096
    s_add_u32 m0, s42, 50176
    s_nop 0
    buffer_load_dwordx4 v10, s[24:27], s41 offen offset:0 lds
    s_mul_i32 s42, s14, 4096
    s_add_u32 m0, s42, 51200
    s_nop 0
    buffer_load_dwordx4 v11, s[24:27], s41 offen offset:0 lds
    s_mul_i32 s42, s14, 4096
    s_add_u32 m0, s42, 52224
    s_nop 0
    buffer_load_dwordx4 v12, s[24:27], s41 offen offset:0 lds
    s_add_u32 s40, s40, 256
    s_add_u32 s41, s41, 131072
    s_waitcnt vmcnt(8)
    s_barrier
    ds_read_b128 v[32:35], v20 offset:0
    ds_read_b64_tr_b16 v[40:41], v24 offset:16384
    ds_read_b64_tr_b16 v[42:43], v24 offset:16896
    s_waitcnt lgkmcnt(0)
    v_mfma_f32_32x32x16_bf16 a[0:15], v[40:43], v[32:35], a[0:15]
    ds_read_b128 v[32:35], v21 offset:0
    ds_read_b64_tr_b16 v[40:41], v24 offset:18432
    ds_read_b64_tr_b16 v[42:43], v24 offset:18944
    s_waitcnt lgkmcnt(0)
    v_mfma_f32_32x32x16_bf16 a[0:15], v[40:43], v[32:35], a[0:15]
    ds_read_b128 v[32:35], v22 offset:0
    ds_read_b64_tr_b16 v[40:41], v24 offset:20480
    ds_read_b64_tr_b16 v[42:43], v24 offset:20992
    s_waitcnt lgkmcnt(0)
    v_mfma_f32_32x32x16_bf16 a[0:15], v[40:43], v[32:35], a[0:15]
    ds_read_b128 v[32:35], v23 offset:0
    ds_read_b64_tr_b16 v[40:41], v24 offset:22528
    ds_read_b64_tr_b16 v[42:43], v24 offset:23040
    s_waitcnt lgkmcnt(0)
    v_mfma_f32_32x32x16_bf16 a[0:15], v[40:43], v[32:35], a[0:15]
    ds_read_b128 v[32:35], v20 offset:8192
    ds_read_b64_tr_b16 v[40:41], v24 offset:24576
    ds_read_b64_tr_b16 v[42:43], v24 offset:25088
    s_waitcnt lgkmcnt(0)
    v_mfma_f32_32x32x16_bf16 a[0:15], v[40:43], v[32:35], a[0:15]
    ds_read_b128 v[32:35], v21 offset:8192
    ds_read_b64_tr_b16 v[40:41], v24 offset:26624
    ds_read_b64_tr_b16 v[42:43], v24 offset:27136
    s_waitcnt lgkmcnt(0)
    v_mfma_f32_32x32x16_bf16 a[0:15], v[40:43], v[32:35], a[0:15]
    ds_read_b128 v[32:35], v22 offset:8192
    ds_read_b64_tr_b16 v[40:41], v24 offset:28672
    ds_read_b64_tr_b16 v[42:43], v24 offset:29184
    s_waitcnt lgkmcnt(0)
    v_mfma_f32_32x32x16_bf16 a[0:15], v[40:43], v[32:35], a[0:15]
    ds_read_b128 v[32:35], v23 offset:8192
    ds_read_b64_tr_b16 v[40:41], v24 offset:30720
    ds_read_b64_tr_b16 v[42:43], v24 offset:31232
    s_waitcnt lgkmcnt(0)
    v_mfma_f32_32x32x16_bf16 a[0:15], v[40:43], v[32:35], a[0:15]
    s_barrier
    s_mul_i32 s42, s14, 2048
    s_add_u32 m0, s42, 0
    s_nop 0
    buffer_load_dwordx4 v6, s[20:23], s40 offen offset:0 lds
    s_mul_i32 s42, s14, 2048
    s_add_u32 m0, s42, 1024
    s_nop 0
    buffer_load_dwordx4 v9, s[20:23], s40 offen offset:0 lds
    s_mul_i32 s42, s14, 2048
    s_add_u32 m0, s42, 8064
    s_nop 0
    buffer_load_dwordx4 v6, s[20:23], s40 offen offset:128 lds
    s_mul_i32 s42, s14, 2048
    s_add_u32 m0, s42, 9088
    s_nop 0
    buffer_load_dwordx4 v9, s[20:23], s40 offen offset:128 lds
    s_mul_i32 s42, s14, 4096
    s_add_u32 m0, s42, 16384
    s_nop 0
    buffer_load_dwordx4 v7, s[24:27], s41 offen offset:0 lds
    s_mul_i32 s42, s14, 4096
    s_add_u32 m0, s42, 17408
    s_nop 0
    buffer_load_dwordx4 v10, s[24:27], s41 offen offset:0 lds
    s_mul_i32 s42, s14, 4096
    s_add_u32 m0, s42, 18432
    s_nop 0
    buffer_load_dwordx4 v11, s[24:27], s41 offen offset:0 lds
    s_mul_i32 s42, s14, 4096
    s_add_u32 m0, s42, 19456
    s_nop 0
    buffer_load_dwordx4 v12, s[24:27], s41 offen offset:0 lds
    s_add_u32 s40, s40, 256
    s_add_u32 s41, s41, 131072
    s_waitcnt vmcnt(8)
    s_barrier
    ds_read_b128 v[32:35], v20 offset:32768
    ds_read_b64_tr_b16 v[40:41], v24 offset:49152
    ds_read_b64_tr_b16 v[42:43], v24 offset:49664
    s_waitcnt lgkmcnt(0)
    v_mfma_f32_32x32x16_bf16 a[0:15], v[40:43], v[32:35], a[0:15]
    ds_read_b128 v[32:35], v21 offset:32768
    ds_read_b64_tr_b16 v[40:41], v24 offset:51200
    ds_read_b64_tr_b16 v[42:43], v24 offset:51712
    s_waitcnt lgkmcnt(0)
    v_mfma_f32_32x32x16_bf16 a[0:15], v[40:43], v[32:35], a[0:15]
    ds_read_b128 v[32:35], v22 offset:32768
    ds_read_b64_tr_b16 v[40:41], v24 offset:53248
    ds_read_b64_tr_b16 v[42:43], v24 offset:53760
    s_waitcnt lgkmcnt(0)
    v_mfma_f32_32x32x16_bf16 a[0:15], v[40:43], v[32:35], a[0:15]
    ds_read_b128 v[32:35], v23 offset:32768
    ds_read_b64_tr_b16 v[40:41], v24 offset:55296
    ds_read_b64_tr_b16 v[42:43], v24 offset:55808
    s_waitcnt lgkmcnt(0)
    v_mfma_f32_32x32x16_bf16 a[0:15], v[40:43], v[32:35], a[0:15]
    ds_read_b128 v[32:35], v20 offset:40960
    ds_read_b64_tr_b16 v[40:41], v24 offset:57344
    ds_read_b64_tr_b16 v[42:43], v24 offset:57856
    s_waitcnt lgkmcnt(0)
    v_mfma_f32_32x32x16_bf16 a[0:15], v[40:43], v[32:35], a[0:15]
    ds_read_b128 v[32:35], v21 offset:40960
    ds_read_b64_tr_b16 v[40:41], v24 offset:59392
    ds_read_b64_tr_b16 v[42:43], v24 offset:59904
    s_waitcnt lgkmcnt(0)
    v_mfma_f32_32x32x16_bf16 a[0:15], v[40:43], v[32:35], a[0:15]
    ds_read_b128 v[32:35], v22 offset:40960
    ds_read_b64_tr_b16 v[40:41], v24 offset:61440
    ds_read_b64_tr_b16 v[42:43], v24 offset:61952
    s_waitcnt lgkmcnt(0)
    v_mfma_f32_32x32x16_bf16 a[0:15], v[40:43], v[32:35], a[0:15]
    ds_read_b128 v[32:35], v23 offset:40960
    ds_read_b64_tr_b16 v[40:41], v24 offset:63488
    ds_read_b64_tr_b16 v[42:43], v24 offset:64000
    s_waitcnt lgkmcnt(0)
    v_mfma_f32_32x32x16_bf16 a[0:15], v[40:43], v[32:35], a[0:15]
    s_barrier
    s_mul_i32 s42, s14, 2048
    s_add_u32 m0, s42, 32768
    s_nop 0
    buffer_load_dwordx4 v6, s[20:23], s40 offen offset:0 lds
    s_mul_i32 s42, s14, 2048
    s_add_u32 m0, s42, 33792
    s_nop 0
    buffer_load_dwordx4 v9, s[20:23], s40 offen offset:0 lds
    s_mul_i32 s42, s14, 2048
    s_add_u32 m0, s42, 40832
    s_nop 0
    buffer_load_dwordx4 v6, s[20:23], s40 offen offset:128 lds
    s_mul_i32 s42, s14, 2048
    s_add_u32 m0, s42, 41856
    s_nop 0
    buffer_load_dwordx4 v9, s[20:23], s40 offen offset:128 lds
    s_mul_i32 s42, s14, 4096
    s_add_u32 m0, s42, 49152
    s_nop 0
    buffer_load_dwordx4 v7, s[24:27], s41 offen offset:0 lds
    s_mul_i32 s42, s14, 4096
    s_add_u32 m0, s42, 50176
    s_nop 0
    buffer_load_dwordx4 v10, s[24:27], s41 offen offset:0 lds
    s_mul_i32 s42, s14, 4096
    s_add_u32 m0, s42, 51200
    s_nop 0
    buffer_load_dwordx4 v11, s[24:27], s41 offen offset:0 lds
    s_mul_i32 s42, s14, 4096
    s_add_u32 m0, s42, 52224
    s_nop 0
    buffer_load_dwordx4 v12, s[24:27], s41 offen offset:0 lds
    s_add_u32 s40, s40, 256
    s_add_u32 s41, s41, 131072
    s_waitcnt vmcnt(8)
    s_barrier
    ds_read_b128 v[32:35], v20 offset:0
    ds_read_b64_tr_b16 v[40:41], v24 offset:16384
    ds_read_b64_tr_b16 v[42:43], v24 offset:16896
    s_waitcnt lgkmcnt(0)
    v_mfma_f32_32x32x16_bf16 a[0:15], v[40:43], v[32:35], a[0:15]
    ds_read_b128 v[32:35], v21 offset:0
    ds_read_b64_tr_b16 v[40:41], v24 offset:18432
    ds_read_b64_tr_b16 v[42:43], v24 offset:18944
    s_waitcnt lgkmcnt(0)
    v_mfma_f32_32x32x16_bf16 a[0:15], v[40:43], v[32:35], a[0:15]
    ds_read_b128 v[32:35], v22 offset:0
    ds_read_b64_tr_b16 v[40:41], v24 offset:20480
    ds_read_b64_tr_b16 v[42:43], v24 offset:20992
    s_waitcnt lgkmcnt(0)
    v_mfma_f32_32x32x16_bf16 a[0:15], v[40:43], v[32:35], a[0:15]
    ds_read_b128 v[32:35], v23 offset:0
    ds_read_b64_tr_b16 v[40:41], v24 offset:22528
    ds_read_b64_tr_b16 v[42:43], v24 offset:23040
    s_waitcnt lgkmcnt(0)
    v_mfma_f32_32x32x16_bf16 a[0:15], v[40:43], v[32:35], a[0:15]
    ds_read_b128 v[32:35], v20 offset:8192
    ds_read_b64_tr_b16 v[40:41], v24 offset:24576
    ds_read_b64_tr_b16 v[42:43], v24 offset:25088
    s_waitcnt lgkmcnt(0)
    v_mfma_f32_32x32x16_bf16 a[0:15], v[40:43], v[32:35], a[0:15]
    ds_read_b128 v[32:35], v21 offset:8192
    ds_read_b64_tr_b16 v[40:41], v24 offset:26624
    ds_read_b64_tr_b16 v[42:43], v24 offset:27136
    s_waitcnt lgkmcnt(0)
    v_mfma_f32_32x32x16_bf16 a[0:15], v[40:43], v[32:35], a[0:15]
    ds_read_b128 v[32:35], v22 offset:8192
    ds_read_b64_tr_b16 v[40:41], v24 offset:28672
    ds_read_b64_tr_b16 v[42:43], v24 offset:29184
    s_waitcnt lgkmcnt(0)
    v_mfma_f32_32x32x16_bf16 a[0:15], v[40:43], v[32:35], a[0:15]
    ds_read_b128 v[32:35], v23 offset:8192
    ds_read_b64_tr_b16 v[40:41], v24 offset:30720
    ds_read_b64_tr_b16 v[42:43], v24 offset:31232
    s_waitcnt lgkmcnt(0)
    v_mfma_f32_32x32x16_bf16 a[0:15], v[40:43], v[32:35], a[0:15]
    s_barrier
    s_waitcnt vmcnt(0)
    s_barrier
    ds_read_b128 v[32:35], v20 offset:32768
    ds_read_b64_tr_b16 v[40:41], v24 offset:49152
    ds_read_b64_tr_b16 v[42:43], v24 offset:49664
    s_waitcnt lgkmcnt(0)
    v_mfma_f32_32x32x16_bf16 a[0:15], v[40:43], v[32:35], a[0:15]
    ds_read_b128 v[32:35], v21 offset:32768
    ds_read_b64_tr_b16 v[40:41], v24 offset:51200
    ds_read_b64_tr_b16 v[42:43], v24 offset:51712
    s_waitcnt lgkmcnt(0)
    v_mfma_f32_32x32x16_bf16 a[0:15], v[40:43], v[32:35], a[0:15]
    ds_read_b128 v[32:35], v22 offset:32768
    ds_read_b64_tr_b16 v[40:41], v24 offset:53248
    ds_read_b64_tr_b16 v[42:43], v24 offset:53760
    s_waitcnt lgkmcnt(0)
    v_mfma_f32_32x32x16_bf16 a[0:15], v[40:43], v[32:35], a[0:15]
    ds_read_b128 v[32:35], v23 offset:32768
    ds_read_b64_tr_b16 v[40:41], v24 offset:55296
    ds_read_b64_tr_b16 v[42:43], v24 offset:55808
    s_waitcnt lgkmcnt(0)
    v_mfma_f32_32x32x16_bf16 a[0:15], v[40:43], v[32:35], a[0:15]
    ds_read_b128 v[32:35], v20 offset:40960
    ds_read_b64_tr_b16 v[40:41], v24 offset:57344
    ds_read_b64_tr_b16 v[42:43], v24 offset:57856
    s_waitcnt lgkmcnt(0)
    v_mfma_f32_32x32x16_bf16 a[0:15], v[40:43], v[32:35], a[0:15]
    ds_read_b128 v[32:35], v21 offset:40960
    ds_read_b64_tr_b16 v[40:41], v24 offset:59392
    ds_read_b64_tr_b16 v[42:43], v24 offset:59904
    s_waitcnt lgkmcnt(0)
    v_mfma_f32_32x32x16_bf16 a[0:15], v[40:43], v[32:35], a[0:15]
    ds_read_b128 v[32:35], v22 offset:40960
    ds_read_b64_tr_b16 v[40:41], v24 offset:61440
    ds_read_b64_tr_b16 v[42:43], v24 offset:61952
    s_waitcnt lgkmcnt(0)
    v_mfma_f32_32x32x16_bf16 a[0:15], v[40:43], v[32:35], a[0:15]
    ds_read_b128 v[32:35], v23 offset:40960
    ds_read_b64_tr_b16 v[40:41], v24 offset:63488
    ds_read_b64_tr_b16 v[42:43], v24 offset:64000
    s_waitcnt lgkmcnt(0)
    v_mfma_f32_32x32x16_bf16 a[0:15], v[40:43], v[32:35], a[0:15]
    s_barrier
    s_nop 15
    s_lshl_b32 s43, s15, 6
    s_lshl_b32 s44, s35, 5
    s_add_u32 s43, s43, s44
    v_add_u32 v50, s43, v13
    v_mul_u32_u24 v50, 1024, v50
    s_lshl_b32 s44, s16, 7
    s_lshl_b32 s45, s36, 6
    s_add_u32 s44, s44, s45
    v_lshlrev_b32 v51, 3, v14
    v_add3_u32 v50, v50, v51, s44

    s_add_u32 s18, s12, 4194304
    s_addc_u32 s19, s13, 0
    s_mov_b32 s20, s18
    s_and_b32 s21, s19, 0xffff
    s_mov_b32 s22, 2097152
    s_mov_b32 s23, 0x00020000

    s_mov_b32 s24, s10
    s_and_b32 s25, s11, 0xffff
    s_mov_b32 s26, 2097152
    s_mov_b32 s27, 0x00020000

    buffer_load_dwordx2 v[64:65], v50, s[20:23], 0 offen offset:0
    buffer_load_dwordx2 v[66:67], v50, s[20:23], 0 offen offset:16
    buffer_load_dwordx2 v[68:69], v50, s[20:23], 0 offen offset:32
    buffer_load_dwordx2 v[70:71], v50, s[20:23], 0 offen offset:48
    s_waitcnt vmcnt(0)
    v_accvgpr_read_b32 v52, a0
    v_cvt_pk_bf16_f32 v52, v52, v52
    v_lshlrev_b32 v52, 16, v52
    v_lshlrev_b32 v56, 16, v64
    v_add_f32 v52, v52, v56
    v_accvgpr_read_b32 v53, a1
    v_cvt_pk_bf16_f32 v53, v53, v53
    v_lshlrev_b32 v53, 16, v53
    v_and_b32 v56, 0xffff0000, v64
    v_add_f32 v53, v53, v56
    v_accvgpr_read_b32 v54, a2
    v_cvt_pk_bf16_f32 v54, v54, v54
    v_lshlrev_b32 v54, 16, v54
    v_lshlrev_b32 v56, 16, v65
    v_add_f32 v54, v54, v56
    v_accvgpr_read_b32 v55, a3
    v_cvt_pk_bf16_f32 v55, v55, v55
    v_lshlrev_b32 v55, 16, v55
    v_and_b32 v56, 0xffff0000, v65
    v_add_f32 v55, v55, v56
    v_cvt_pk_bf16_f32 v60, v52, v53
    v_cvt_pk_bf16_f32 v61, v54, v55
    buffer_store_dwordx2 v[60:61], v50, s[24:27], 0 offen offset:0
    v_accvgpr_read_b32 v52, a4
    v_cvt_pk_bf16_f32 v52, v52, v52
    v_lshlrev_b32 v52, 16, v52
    v_lshlrev_b32 v56, 16, v66
    v_add_f32 v52, v52, v56
    v_accvgpr_read_b32 v53, a5
    v_cvt_pk_bf16_f32 v53, v53, v53
    v_lshlrev_b32 v53, 16, v53
    v_and_b32 v56, 0xffff0000, v66
    v_add_f32 v53, v53, v56
    v_accvgpr_read_b32 v54, a6
    v_cvt_pk_bf16_f32 v54, v54, v54
    v_lshlrev_b32 v54, 16, v54
    v_lshlrev_b32 v56, 16, v67
    v_add_f32 v54, v54, v56
    v_accvgpr_read_b32 v55, a7
    v_cvt_pk_bf16_f32 v55, v55, v55
    v_lshlrev_b32 v55, 16, v55
    v_and_b32 v56, 0xffff0000, v67
    v_add_f32 v55, v55, v56
    v_cvt_pk_bf16_f32 v60, v52, v53
    v_cvt_pk_bf16_f32 v61, v54, v55
    buffer_store_dwordx2 v[60:61], v50, s[24:27], 0 offen offset:16
    v_accvgpr_read_b32 v52, a8
    v_cvt_pk_bf16_f32 v52, v52, v52
    v_lshlrev_b32 v52, 16, v52
    v_lshlrev_b32 v56, 16, v68
    v_add_f32 v52, v52, v56
    v_accvgpr_read_b32 v53, a9
    v_cvt_pk_bf16_f32 v53, v53, v53
    v_lshlrev_b32 v53, 16, v53
    v_and_b32 v56, 0xffff0000, v68
    v_add_f32 v53, v53, v56
    v_accvgpr_read_b32 v54, a10
    v_cvt_pk_bf16_f32 v54, v54, v54
    v_lshlrev_b32 v54, 16, v54
    v_lshlrev_b32 v56, 16, v69
    v_add_f32 v54, v54, v56
    v_accvgpr_read_b32 v55, a11
    v_cvt_pk_bf16_f32 v55, v55, v55
    v_lshlrev_b32 v55, 16, v55
    v_and_b32 v56, 0xffff0000, v69
    v_add_f32 v55, v55, v56
    v_cvt_pk_bf16_f32 v60, v52, v53
    v_cvt_pk_bf16_f32 v61, v54, v55
    buffer_store_dwordx2 v[60:61], v50, s[24:27], 0 offen offset:32
    v_accvgpr_read_b32 v52, a12
    v_cvt_pk_bf16_f32 v52, v52, v52
    v_lshlrev_b32 v52, 16, v52
    v_lshlrev_b32 v56, 16, v70
    v_add_f32 v52, v52, v56
    v_accvgpr_read_b32 v53, a13
    v_cvt_pk_bf16_f32 v53, v53, v53
    v_lshlrev_b32 v53, 16, v53
    v_and_b32 v56, 0xffff0000, v70
    v_add_f32 v53, v53, v56
    v_accvgpr_read_b32 v54, a14
    v_cvt_pk_bf16_f32 v54, v54, v54
    v_lshlrev_b32 v54, 16, v54
    v_lshlrev_b32 v56, 16, v71
    v_add_f32 v54, v54, v56
    v_accvgpr_read_b32 v55, a15
    v_cvt_pk_bf16_f32 v55, v55, v55
    v_lshlrev_b32 v55, 16, v55
    v_and_b32 v56, 0xffff0000, v71
    v_add_f32 v55, v55, v56
    v_cvt_pk_bf16_f32 v60, v52, v53
    v_cvt_pk_bf16_f32 v61, v54, v55
    buffer_store_dwordx2 v[60:61], v50, s[24:27], 0 offen offset:48
K5_END:
    s_endpgm
.section .rodata,"a"
.p2align 6
.amdhsa_kernel k1_kernel
  .amdhsa_next_free_vgpr 112
  .amdhsa_next_free_sgpr 40
  .amdhsa_accum_offset 112
  .amdhsa_group_segment_fixed_size 0
  .amdhsa_kernarg_size 104
  .amdhsa_user_sgpr_count 2
  .amdhsa_user_sgpr_kernarg_segment_ptr 1
  .amdhsa_system_sgpr_workgroup_id_x 1
.end_amdhsa_kernel

.p2align 6
.amdhsa_kernel k2_kernel
  .amdhsa_next_free_vgpr 132
  .amdhsa_next_free_sgpr 40
  .amdhsa_accum_offset 100
  .amdhsa_group_segment_fixed_size 0
  .amdhsa_kernarg_size 104
  .amdhsa_user_sgpr_count 2
  .amdhsa_user_sgpr_kernarg_segment_ptr 1
  .amdhsa_system_sgpr_workgroup_id_x 1
.end_amdhsa_kernel

.p2align 6
.amdhsa_kernel k3_kernel
  .amdhsa_next_free_vgpr 152
  .amdhsa_next_free_sgpr 48
  .amdhsa_accum_offset 152
  .amdhsa_group_segment_fixed_size 0
  .amdhsa_kernarg_size 104
  .amdhsa_user_sgpr_count 2
  .amdhsa_user_sgpr_kernarg_segment_ptr 1
  .amdhsa_system_sgpr_workgroup_id_x 1
.end_amdhsa_kernel

.p2align 6
.amdhsa_kernel k4_kernel
  .amdhsa_next_free_vgpr 136
  .amdhsa_next_free_sgpr 48
  .amdhsa_accum_offset 72
  .amdhsa_group_segment_fixed_size 0
  .amdhsa_kernarg_size 104
  .amdhsa_user_sgpr_count 2
  .amdhsa_user_sgpr_kernarg_segment_ptr 1
  .amdhsa_system_sgpr_workgroup_id_x 1
.end_amdhsa_kernel

.p2align 6
.amdhsa_kernel k5_kernel
  .amdhsa_next_free_vgpr 88
  .amdhsa_next_free_sgpr 48
  .amdhsa_accum_offset 72
  .amdhsa_group_segment_fixed_size 0
  .amdhsa_kernarg_size 104
  .amdhsa_user_sgpr_count 2
  .amdhsa_user_sgpr_kernarg_segment_ptr 1
  .amdhsa_system_sgpr_workgroup_id_x 1
.end_amdhsa_kernel
```
